```python
import torch

def _softmax(x, axis=-1):
    return torch.softmax(x, dim=axis)
def _gelu(x):
    return torch.nn.functional.gelu(x, approximate="tanh")
def _silu(x):
    return torch.nn.functional.silu(x)
def _sigmoid(x):
    return torch.sigmoid(x)
def _layernorm(x, axis=-1, eps=1e-5):
    m = x.mean(dim=axis, keepdim=True)
    v = x.var(dim=axis, keepdim=True, unbiased=False)
    return (x - m) / torch.sqrt(v + eps)
def _scatter_add(tgt, idx, src, axis=0):
    return tgt.clone().index_add_(axis, idx, src)
def _segment_sum(src, seg, n):
    out = torch.zeros((n,) + src.shape[1:], dtype=src.dtype)
    return out.index_add_(0, seg, src)
def _pad(x, pw):
    flat = tuple(v for pair in reversed(pw) for v in pair)
    return torch.nn.functional.pad(x, flat)

kernel_name = 'standalone__qk_norm__prompt'

def setup_inputs():

    _w = (lambda a: (lambda t: t.to(torch.bfloat16) if t.is_floating_point() else t)(torch.as_tensor(a)))
    B, H, S, D = 2, 16, 2048, 448
    Dh = D // H
    return {
        "q": _w((lambda *s: torch.randn(*s, dtype=torch.bfloat16) * 0.05)(B, H, S, Dh)),
        "k": _w((lambda *s: torch.randn(*s, dtype=torch.bfloat16) * 0.05)(B, H, S, Dh)),
        "v": _w((lambda *s: torch.randn(*s, dtype=torch.bfloat16) * 1.6)(B, H, S, Dh)),
        "t": _w(torch.abs((lambda *s: torch.randn(*s, dtype=torch.bfloat16) * 1.6)(H)) + 1.0),
    }

def reference(q, k, v, t):
    eps = 1e-6
    qn = q / (torch.sqrt((q * q).sum(axis=-1, keepdims=True)) + eps)
    kn = k / (torch.sqrt((k * k).sum(axis=-1, keepdims=True)) + eps)
    logits = torch.einsum('bhqd,bhkd->bhqk', qn, kn) * t[None, :, None, None]
    attn = _softmax(logits, axis=-1)
    return torch.einsum('bhqk,bhkd->bhqd', attn, v)
```

```asm
; @launch grid=(256,1,1) block=(512,1,1) lds=161792
.amdgcn_target "amdgcn-amd-amdhsa--gfx950"
.text
.globl standalone__qk_norm__prompt_kernel
.p2align 8
.type standalone__qk_norm__prompt_kernel,@function
standalone__qk_norm__prompt_kernel:
    s_load_dwordx4 s[4:7], s[0:1], 0
    s_load_dwordx4 s[8:11], s[0:1], 16
    s_load_dwordx2 s[12:13], s[0:1], 32
    s_cmp_ge_u32 s2, 256
    s_cbranch_scc1 L_end
    v_lshrrev_b32 v7, 6, v0
    v_and_b32 v0, 63, v0
    v_readfirstlane_b32 s32, v7
    s_getpc_b64 s[14:15]
L_pc:
    s_and_b32 s3, s2, 248
    v_add_u32 v13, s3, v7
    v_min_u32 v13, (L_cold - L_pc) / 128, v13
    v_lshlrev_b32 v13, 7, v13
    global_load_dword v236, v13, s[14:15]
    s_and_b32 s3, s2, 7
    s_lshr_b32 s33, s2, 6
    s_lshl2_add_u32 s33, s3, s33
    s_mov_b32 s56, 0
    v_lshlrev_b32 v1, 4, v0
L_restart:
    s_movk_i32 s47, 3584
    s_mov_b32 s50, 114688
    s_mov_b32 s51, 0x00020000
    s_mul_i32 s3, s33, s50
    s_mul_i32 s41, s32, s47
    s_add_u32 s41, s41, 131072
    s_and_b32 s36, s32, 3
    s_mul_i32 s38, s36, s47
    s_and_b32 s46, s2, 56
    s_mulk_i32 s46, 1792
    s_add_u32 s45, s46, s38
    s_and_b32 s47, s33, 15
    s_lshl_b32 s47, s47, 1
    v_mov_b32 v241, s47
    s_mov_b32 m0, s41
    s_cmp_lt_u32 s32, 4
    s_cselect_b32 s35, 1, 0
    s_cselect_b32 s46, s38, s45
    s_waitcnt lgkmcnt(0)
    s_cselect_b32 s48, s6, s4
    s_cselect_b32 s49, s7, s5
    global_load_ushort v241, v241, s[10:11]
    s_add_u32 s48, s48, s3
    s_addc_u32 s49, s49, 0
    buffer_load_dwordx4 v1, s[48:51], s46 offen offset:0 lds
    buffer_load_dwordx4 v1, s[48:51], s46 offen offset:1024 lds
    buffer_load_dwordx4 v1, s[48:51], s46 offen offset:2048 lds
    s_mov_b32 exec_hi, 0
    buffer_load_dwordx4 v1, s[48:51], s46 offen offset:3072 lds
    s_mov_b32 exec_hi, -1
    s_add_u32 s20, s6, s3
    s_addc_u32 s21, s7, 0
    s_mov_b32 s22, s50
    s_mov_b32 s23, 0x00020000
    s_add_u32 s24, s8, s3
    s_addc_u32 s25, s9, 0
    s_mov_b32 s26, s50
    s_mov_b32 s27, 0x00020000
    s_add_u32 s28, s12, s3
    s_addc_u32 s29, s13, 0
    s_mov_b32 s30, s50
    s_mov_b32 s31, 0x00020000
    s_mul_i32 s46, s35, 1792
    s_add_u32 s45, s45, s46
    s_mov_b32 s52, 0x7f7f7f7f
    s_mov_b32 s53, s52
    s_lshl_b32 s40, s32, 11
    v_lshrrev_b32 v7, 3, v0
    v_and_b32 v13, 15, v0
    v_sub_u32 v2, v0, v7
    v_lshrrev_b32 v14, 4, v0
    v_lshlrev_b32 v2, 4, v2
    v_lshl_add_u32 v13, v14, 7, v13
    v_mov_b32 v208, 0x3f80
    v_mov_b32 v209, 0
    v_lshl_add_u32 v13, v13, 7, s40
    ds_write_b64 v13, v[208:209] offset:112
    s_lshl_b32 s46, s32, 8
    s_add_u32 s46, s46, 159744
    v_lshl_add_u32 v243, v0, 2, s46
    v_mov_b32 v246, 0
    v_and_b32 v7, 3, v0
    v_bfe_u32 v14, v0, 2, 2
    ds_write_b32 v243, v246
    v_lshl_add_u32 v14, v7, 2, v14
    v_mul_u32_u24 v8, 56, v0
    v_and_or_b32 v14, v0, 48, v14
    v_lshlrev_b32 v7, 4, v7
    v_mul_u32_u24 v9, 56, v14
    v_mov_b32 v10, 0xffff
    v_mov_b32 v11, 0
    v_add_u32 v8, s41, v8
    v_add_u32 v9, s41, v9
    v_lshlrev_b64 v[10:11], v7, v[10:11]
    v_lshrrev_b32 v15, 5, v0
    s_lshl_b32 s60, s36, 12
    s_cmp_eq_u32 s35, 0
    s_cselect_b32 s59, 49152, 0
    s_add_u32 s60, s60, 65536
    s_add_u32 s59, s59, s60
    v_mul_u32_u24 v3, 1536, v15
    v_mov_b32 v190, 0x3f803f80
    v_add3_u32 v3, v3, v1, s59
    v_mov_b32 v191, v190
    s_mov_b32 s44, 0x358637bd
    s_mov_b32 s64, 0x22222222
    s_mov_b32 s65, s64
    s_lshl_b64 s[66:67], s[64:65], 1
    s_lshl_b64 s[68:69], s[64:65], 2
    v_mul_u32_u24 v7, 1760, v15
    s_lshl_b32 s46, s35, 11
    s_add_u32 s46, s46, s60
    s_add_u32 s46, s46, 49152
    v_sub_u32 v12, v8, v7
    v_add_u32 v247, s46, v1
    v_mov_b64 v[172:173], 0
    v_xor_b32 v242, 0x800, v247
    v_mov_b64 v[174:175], 0
    s_mov_b32 s46, 0xc8b75140
    s_mov_b32 s47, 0xead9e362
    v_mfma_i32_32x32x32_i8 v[32:47], v[172:175], v[172:175], 0
    v_and_b32 v244, 7, v0
    v_lshlrev_b32 v7, 1, v0
    v_lshlrev_b32 v244, 2, v244
    v_and_b32 v5, 40, v0
    v_and_or_b32 v7, v7, 32, v244
    v_lshlrev_b32 v5, 4, v5
    v_lshrrev_b64 v[206:207], v7, s[46:47]
    v_mfma_i32_32x32x32_i8 v[48:63], v[172:175], v[172:175], 0
    s_lshl_b32 s47, s35, 13
    v_and_b32 v206, 15, v206
    v_mul_u32_u24 v244, 65, v244
    v_add_u32 v244, 159744, v244
    v_lshl_add_u32 v5, v206, 3, v5
    v_mov_b32 v246, 1
    v_add_u32 v5, s47, v5
    s_add_u32 s47, s47, 65536
    v_mov_b32 v6, 0xdddddddd
    v_add_u32 v4, s47, v1
    s_lshl_b32 s46, s32, 12
    s_add_u32 s46, s46, 65536
    v_add_u32 v248, s46, v1
    v_add_u32 v250, s41, v1
    v_xor_b32 v249, 0x4000, v248
    s_mov_b32 s37, 0
    s_movk_i32 s59, 0x4000
    s_mul_i32 s39, s32, 1792
    s_add_u32 s40, s40, 0x4000
    s_add_u32 s39, s39, 14336
    s_cmp_eq_u32 s35, 0
    s_cbranch_scc1 L_st4
    s_lshl_b32 s46, s36, 11
    s_mul_i32 s47, s36, 1792
    s_mov_b32 m0, s46
    s_mov_b64 exec, s[52:53]
    buffer_load_dwordx4 v2, s[24:27], s47 offen lds
    s_add_u32 m0, s46, 128
    s_nop 0
    buffer_load_dwordx4 v2, s[24:27], s47 offen offset:896 lds
    s_mov_b64 exec, -1
    s_lshl_b32 s46, s36, 11
    s_mul_i32 s47, s36, 1792
    s_add_u32 s46, s46, 8192
    s_add_u32 s47, s47, 7168
    s_mov_b32 m0, s46
    s_mov_b64 exec, s[52:53]
    buffer_load_dwordx4 v2, s[24:27], s47 offen lds
    s_add_u32 m0, s46, 128
    s_nop 0
    buffer_load_dwordx4 v2, s[24:27], s47 offen offset:896 lds
    s_mov_b64 exec, -1
    s_add_u32 s38, s38, 28672
    s_mov_b32 s43, 1.0
    s_setprio 3
    s_waitcnt vmcnt(4)
    s_call_b64 s[54:55], L_prep
    v_lshlrev_b32 v241, 16, v241
    s_nop 0
    v_readfirstlane_b32 s57, v241
    s_nop 1
    s_and_b32 s57, s57, 0x7fffffff
    s_cmp_gt_u32 s57, 0x41800000
    s_cselect_b32 s57, 1, 0
    s_waitcnt vmcnt(0)
    s_mov_b32 m0, s41
    s_nop 0
    buffer_load_dwordx4 v1, s[20:23], s38 offen offset:0 lds
    buffer_load_dwordx4 v1, s[20:23], s38 offen offset:1024 lds
    buffer_load_dwordx4 v1, s[20:23], s38 offen offset:2048 lds
    s_mov_b32 exec_hi, 0
    buffer_load_dwordx4 v1, s[20:23], s38 offen offset:3072 lds
    s_mov_b32 exec_hi, -1
    s_add_u32 s38, s38, 28672
    s_branch L_st5
L_st4:
    s_add_u32 s60, s60, 32768
    s_add_u32 s58, s38, 14336
    s_add_u32 s38, s38, 43008
    s_sub_u32 s46, s41, s60
    v_subrev_u32 v251, s46, v8
    v_subrev_u32 v252, s46, v9
    s_waitcnt vmcnt(4)
    v_lshlrev_b32 v241, 16, v241
    v_mul_f32 v7, 0x3fb8aa3b, v241
    v_readfirstlane_b32 s57, v241
    v_readfirstlane_b32 s43, v7
    v_mov_b32 v191, 0
    s_and_b32 s57, s57, 0x7fffffff
    s_or_b32 s47, s43, 0x80000000
    s_lshr_b32 s47, s47, 16
    s_cmp_gt_u32 s57, 0x41800000
    s_cselect_b32 s47, 0, s47
    s_cselect_b32 s57, 1, 0
    v_mov_b32 v190, s47
    s_setprio 2
    s_waitcnt vmcnt(0)
    s_call_b64 s[54:55], L_prep
    s_mov_b32 m0, s60
    s_nop 0
    buffer_load_dwordx4 v1, s[20:23], s58 offen offset:0 lds
    buffer_load_dwordx4 v1, s[20:23], s58 offen offset:1024 lds
    buffer_load_dwordx4 v1, s[20:23], s58 offen offset:2048 lds
    s_mov_b32 exec_hi, 0
    buffer_load_dwordx4 v1, s[20:23], s58 offen offset:3072 lds
    s_mov_b32 exec_hi, -1
    s_mov_b32 s43, 1.0
L_st5:
    s_waitcnt lgkmcnt(0)
    s_barrier
    ds_read_b128 v[16:19], v242
    ds_read_b128 v[128:131], v4 offset:0
    ds_read_b128 v[24:27], v242 offset:1024
    ds_read_b128 v[132:135], v4 offset:1024
    ds_read_b128 v[20:23], v247
    ds_read_b128 v[28:31], v247 offset:1024
    v_mov_b32 v190, 0x3f803f80
    v_mov_b32 v191, 0x3f803f80
    s_cmp_lg_u32 s57, 0
    s_cbranch_scc1 L_special
L_fill:
    s_waitcnt lgkmcnt(4)
    v_mfma_f32_32x32x16_bf16 v[64:79], v[128:131], v[16:19], 0
    ds_read_b128 v[136:139], v4 offset:2048
    s_waitcnt lgkmcnt(3)
    v_mfma_f32_32x32x16_bf16 v[64:79], v[132:135], v[24:27], v[64:79]
    ds_read_b128 v[140:143], v4 offset:3072
    ds_read_b64_tr_b16 v[144:145], v5 offset:0
    ds_read_b64_tr_b16 v[146:147], v5 offset:256
    ds_read_b64_tr_b16 v[148:149], v5 offset:1024
    ds_read_b64_tr_b16 v[150:151], v5 offset:1280
    v_and_b32 v3, 0xffff7fff, v3
    s_setprio 3
    s_cmp_eq_u32 s35, 0
    s_cbranch_scc1 L_pf
    s_setprio 3
L_pf:
    s_nop 1
    s_waitcnt lgkmcnt(4)
    v_mfma_f32_32x32x16_bf16 v[80:95], v[128:131], v[20:23], 0
    v_exp_f32 v64, v64
    v_exp_f32 v65, v65
    ds_read_b64_tr_b16 v[152:153], v5 offset:2048
    ds_read_b64_tr_b16 v[154:155], v5 offset:2304
    v_exp_f32 v66, v66
    v_mfma_f32_32x32x16_bf16 v[80:95], v[132:135], v[28:31], v[80:95]
    v_exp_f32 v67, v67
    v_exp_f32 v68, v68
    ds_read_b64_tr_b16 v[156:157], v5 offset:3072
    ds_read_b64_tr_b16 v[158:159], v5 offset:3328
    v_exp_f32 v69, v69
    ds_read_b128 v[128:131], v4 offset:4096
    v_exp_f32 v70, v70
    v_exp_f32 v71, v71
    s_mov_b32 m0, s40
    s_mov_b64 exec, s[52:53]
    buffer_load_dwordx4 v2, s[24:27], s39 offen lds
    s_mov_b64 exec, -1
    ds_read_b128 v[132:135], v4 offset:5120
    v_mfma_f32_32x32x16_bf16 v[96:111], v[136:139], v[16:19], 0
    v_exp_f32 v72, v72
    v_exp_f32 v73, v73
    v_exp_f32 v74, v74
    s_add_u32 m0, s40, 128
    s_mov_b64 exec, s[52:53]
    buffer_load_dwordx4 v2, s[24:27], s39 offen offset:896 lds
    s_mov_b64 exec, -1
    s_add_u32 s39, s39, 14336
    v_mfma_f32_32x32x16_bf16 v[96:111], v[140:143], v[24:27], v[96:111]
    v_exp_f32 v75, v75
    v_exp_f32 v76, v76
    s_waitcnt lgkmcnt(6)
    ds_read_b64_tr_b16 v[160:161], v5 offset:4096
    ds_read_b64_tr_b16 v[162:163], v5 offset:4352
    v_exp_f32 v77, v77
    v_smfmac_f32_32x32x32_bf16 v[32:47], v[144:147], v[64:71], v6
    v_exp_f32 v78, v78
    v_exp_f32 v79, v79
    s_cmp_eq_u32 s35, 0
    s_cbranch_scc1 L_B1
    s_branch L_A1
L_prep:
    ds_read_b64 v[176:177], v8 offset:0
    ds_read_b64 v[178:179], v8 offset:8
    ds_read_b64 v[180:181], v8 offset:16
    ds_read_b64 v[182:183], v8 offset:24
    ds_read_b64 v[184:185], v8 offset:32
    ds_read_b64 v[186:187], v8 offset:40
    ds_read_b64 v[188:189], v8 offset:48
    ds_read_b64_tr_b16 v[192:193], v9 offset:0
    ds_read_b64_tr_b16 v[194:195], v9 offset:8
    ds_read_b64_tr_b16 v[196:197], v9 offset:16
    ds_read_b64_tr_b16 v[198:199], v9 offset:24
    ds_read_b64_tr_b16 v[200:201], v9 offset:32
    ds_read_b64_tr_b16 v[202:203], v9 offset:40
    ds_read_b64_tr_b16 v[204:205], v9 offset:48
    s_waitcnt lgkmcnt(13)
    v_mfma_f32_4x4x4_16b_bf16 v[208:211], v[176:177], v[176:177], 0
    s_waitcnt lgkmcnt(12)
    s_nop 0
    v_mfma_f32_4x4x4_16b_bf16 v[208:211], v[178:179], v[178:179], v[208:211]
    s_waitcnt lgkmcnt(11)
    s_nop 0
    v_mfma_f32_4x4x4_16b_bf16 v[208:211], v[180:181], v[180:181], v[208:211]
    s_waitcnt lgkmcnt(10)
    s_nop 0
    v_mfma_f32_4x4x4_16b_bf16 v[208:211], v[182:183], v[182:183], v[208:211]
    s_waitcnt lgkmcnt(9)
    s_nop 0
    v_mfma_f32_4x4x4_16b_bf16 v[208:211], v[184:185], v[184:185], v[208:211]
    s_waitcnt lgkmcnt(8)
    s_nop 0
    v_mfma_f32_4x4x4_16b_bf16 v[208:211], v[186:187], v[186:187], v[208:211]
    s_waitcnt lgkmcnt(7)
    s_nop 0
    v_mfma_f32_4x4x4_16b_bf16 v[208:211], v[188:189], v[188:189], v[208:211]
    s_nop 4
    v_cndmask_b32 v14, v208, v209, s[64:65]
    v_cndmask_b32 v14, v14, v210, s[66:67]
    v_cndmask_b32 v14, v14, v211, s[68:69]
    v_sqrt_f32 v14, v14
    s_nop 0
    v_add_f32 v14, s44, v14
    v_rcp_f32 v15, v14
    s_nop 0
    v_mul_f32 v15, s43, v15
    v_cvt_pk_bf16_f32 v15, v15, v15
    v_and_b32 v206, v15, v10
    v_and_b32 v207, v15, v11
    s_waitcnt lgkmcnt(0)
    s_nop 0
    v_mfma_f32_4x4x4_16b_bf16 v[208:211], v[192:193], v[206:207], 0
    v_mfma_f32_4x4x4_16b_bf16 v[212:215], v[194:195], v[206:207], 0
    v_mfma_f32_4x4x4_16b_bf16 v[216:219], v[196:197], v[206:207], 0
    v_mfma_f32_4x4x4_16b_bf16 v[220:223], v[198:199], v[206:207], 0
    v_mfma_f32_4x4x4_16b_bf16 v[224:227], v[200:201], v[206:207], 0
    v_mfma_f32_4x4x4_16b_bf16 v[228:231], v[202:203], v[206:207], 0
    v_mfma_f32_4x4x4_16b_bf16 v[232:235], v[204:205], v[206:207], 0
    v_cvt_pk_bf16_f32 v176, v208, v209
    v_cvt_pk_bf16_f32 v177, v210, v211
    v_cvt_pk_bf16_f32 v178, v212, v213
    v_cvt_pk_bf16_f32 v179, v214, v215
    ds_write_b128 v3, v[176:179] offset:0
    v_cvt_pk_bf16_f32 v180, v216, v217
    v_cvt_pk_bf16_f32 v181, v218, v219
    v_cvt_pk_bf16_f32 v182, v220, v221
    v_cvt_pk_bf16_f32 v183, v222, v223
    ds_write_b128 v3, v[180:183] offset:512
    v_cvt_pk_bf16_f32 v184, v224, v225
    v_cvt_pk_bf16_f32 v185, v226, v227
    v_cvt_pk_bf16_f32 v186, v228, v229
    v_cvt_pk_bf16_f32 v187, v230, v231
    ds_write_b128 v3, v[184:187] offset:1024
    v_cvt_pk_bf16_f32 v188, v232, v233
    v_cvt_pk_bf16_f32 v189, v234, v235
    ds_write_b128 v3, v[188:191] offset:1536
    v_xor_b32 v3, 0x8000, v3
    s_setpc_b64 s[54:55]
.p2align 5
L_A1:
    v_exp_f32 v80, v80
    v_exp_f32 v81, v81
    v_smfmac_f32_32x32x32_bf16 v[32:47], v[148:151], v[72:79], v6
    s_setprio 2
    ds_read_b64_tr_b16 v[164:165], v5 offset:5120
    v_exp_f32 v82, v82
    v_exp_f32 v83, v83
    v_exp_f32 v84, v84
    v_exp_f32 v85, v85
    v_mfma_f32_32x32x16_bf16 v[112:127], v[136:139], v[20:23], 0
    ds_read_b64_tr_b16 v[166:167], v5 offset:5376
    v_exp_f32 v86, v86
    v_exp_f32 v87, v87
    v_exp_f32 v88, v88
    v_exp_f32 v89, v89
    v_mfma_f32_32x32x16_bf16 v[112:127], v[140:143], v[28:31], v[112:127]
    s_waitcnt vmcnt(2)
    ds_read2_b64 v[176:179], v8 offset0:0 offset1:1
    v_exp_f32 v90, v90
    ds_read2_b64 v[180:183], v8 offset0:2 offset1:3
    v_exp_f32 v91, v91
    v_exp_f32 v92, v92
    v_exp_f32 v93, v93
    v_smfmac_f32_32x32x32_bf16 v[48:63], v[144:147], v[80:87], v6
    ds_read2_b64 v[184:187], v8 offset0:4 offset1:5
    ds_read_b64 v[188:189], v8 offset:48
    v_exp_f32 v94, v94
    v_exp_f32 v95, v95
    v_exp_f32 v96, v96
    v_exp_f32 v97, v97
    v_smfmac_f32_32x32x32_bf16 v[48:63], v[148:151], v[88:95], v6
    ds_read_b128 v[136:139], v4 offset:6144
    s_waitcnt lgkmcnt(1)
    ds_read_b64_tr_b16 v[192:193], v9 offset:0
    v_exp_f32 v98, v98
    v_exp_f32 v99, v99
    v_exp_f32 v100, v100
    v_mfma_f32_4x4x4_16b_bf16 v[208:211], v[176:177], v[176:177], 0
    v_exp_f32 v101, v101
    v_mfma_f32_32x32x16_bf16 v[64:79], v[128:131], v[16:19], 0
    ds_read_b128 v[140:143], v4 offset:7168
    ds_read_b64_tr_b16 v[194:195], v9 offset:8
    v_exp_f32 v102, v102
    v_exp_f32 v103, v103
    v_exp_f32 v104, v104
    v_mfma_f32_4x4x4_16b_bf16 v[208:211], v[178:179], v[178:179], v[208:211]
    v_exp_f32 v105, v105
    v_mfma_f32_32x32x16_bf16 v[64:79], v[132:135], v[24:27], v[64:79]
    ds_read_b64_tr_b16 v[168:169], v5 offset:6144
    ds_read_b64_tr_b16 v[196:197], v9 offset:16
    v_exp_f32 v106, v106
    v_exp_f32 v107, v107
    v_exp_f32 v108, v108
    v_mfma_f32_4x4x4_16b_bf16 v[208:211], v[180:181], v[180:181], v[208:211]
    v_exp_f32 v109, v109
    v_smfmac_f32_32x32x32_bf16 v[32:47], v[152:155], v[96:103], v6
    ds_read_b64_tr_b16 v[170:171], v5 offset:6400
    ds_read_b64_tr_b16 v[198:199], v9 offset:24
    v_exp_f32 v110, v110
    v_exp_f32 v111, v111
    v_mfma_f32_4x4x4_16b_bf16 v[208:211], v[182:183], v[182:183], v[208:211]
    v_exp_f32 v112, v112
    v_exp_f32 v113, v113
    v_smfmac_f32_32x32x32_bf16 v[32:47], v[156:159], v[104:111], v6
    s_setprio 1
    ds_read_b64_tr_b16 v[172:173], v5 offset:7168
    v_exp_f32 v114, v114
    v_exp_f32 v115, v115
    v_exp_f32 v116, v116
    v_mfma_f32_4x4x4_16b_bf16 v[208:211], v[184:185], v[184:185], v[208:211]
    v_exp_f32 v117, v117
    v_mfma_f32_32x32x16_bf16 v[80:95], v[128:131], v[20:23], 0
    ds_read_b64_tr_b16 v[200:201], v9 offset:32
    ds_read_b64_tr_b16 v[202:203], v9 offset:40
    v_exp_f32 v118, v118
    v_exp_f32 v119, v119
    v_exp_f32 v120, v120
    v_mfma_f32_4x4x4_16b_bf16 v[208:211], v[186:187], v[186:187], v[208:211]
    v_exp_f32 v121, v121
    v_mfma_f32_32x32x16_bf16 v[80:95], v[132:135], v[28:31], v[80:95]
    ds_read_b64_tr_b16 v[174:175], v5 offset:7424
    s_waitcnt vmcnt(0)
    ds_add_u32 v243, v246
    ds_read_b64_tr_b16 v[204:205], v9 offset:48
    v_exp_f32 v122, v122
    v_exp_f32 v123, v123
    v_mfma_f32_4x4x4_16b_bf16 v[208:211], v[188:189], v[188:189], v[208:211]
    v_exp_f32 v124, v124
    v_exp_f32 v125, v125
    v_exp_f32 v126, v126
    v_smfmac_f32_32x32x32_bf16 v[48:63], v[152:155], v[112:119], v6
    v_exp_f32 v127, v127
    v_exp_f32 v64, v64
    s_waitcnt lgkmcnt(8)
    v_exp_f32 v65, v65
    v_smfmac_f32_32x32x32_bf16 v[48:63], v[156:159], v[120:127], v6
    v_exp_f32 v66, v66
    v_exp_f32 v67, v67
    v_cndmask_b32 v14, v208, v209, s[64:65]
    v_exp_f32 v68, v68
    v_cndmask_b32 v14, v14, v210, s[66:67]
    v_cndmask_b32 v14, v14, v211, s[68:69]
    v_exp_f32 v69, v69
    v_sqrt_f32 v14, v14
    v_exp_f32 v70, v70
    v_add_f32 v14, s44, v14
    v_mfma_f32_32x32x16_bf16 v[96:111], v[136:139], v[16:19], 0
    v_exp_f32 v71, v71
    v_exp_f32 v72, v72
    v_rcp_f32 v15, v14
    v_exp_f32 v73, v73
    v_mfma_f32_32x32x16_bf16 v[96:111], v[140:143], v[24:27], v[96:111]
    v_exp_f32 v74, v74
    v_cvt_pk_bf16_f32 v15, v15, v15
    v_and_b32 v206, v15, v10
    v_and_b32 v207, v15, v11
    v_exp_f32 v75, v75
    v_exp_f32 v76, v76
    v_mfma_f32_4x4x4_16b_bf16 v[208:211], v[192:193], v[206:207], 0
    v_exp_f32 v77, v77
    v_smfmac_f32_32x32x32_bf16 v[32:47], v[160:163], v[64:71], v6
    s_setprio 1
    s_setprio 0
    ds_read_b32 v245, v244
    v_exp_f32 v78, v78
    v_exp_f32 v79, v79
    v_mfma_f32_4x4x4_16b_bf16 v[212:215], v[194:195], v[206:207], 0
    v_exp_f32 v80, v80
    v_exp_f32 v81, v81
    v_mfma_f32_4x4x4_16b_bf16 v[216:219], v[196:197], v[206:207], 0
    v_smfmac_f32_32x32x32_bf16 v[32:47], v[164:167], v[72:79], v6
    s_setprio 3
    s_waitcnt lgkmcnt(0)
    v_cmp_ge_u32 vcc, 0, v245
    s_cbranch_vccnz L_spinp0
L_backp0:
    ds_read_b128 v[128:131], v4 offset:16384
    ds_read_b128 v[132:135], v4 offset:17408
    v_exp_f32 v82, v82
    v_exp_f32 v83, v83
    v_cvt_pk_bf16_f32 v176, v208, v209
    v_exp_f32 v84, v84
    v_cvt_pk_bf16_f32 v177, v210, v211
    v_exp_f32 v85, v85
    v_mfma_f32_32x32x16_bf16 v[112:127], v[136:139], v[20:23], 0
    ds_read_b64_tr_b16 v[144:145], v5 offset:16384
    ds_read_b64_tr_b16 v[146:147], v5 offset:16640
    s_add_u32 m0, s40, 0x4000
    s_mov_b64 exec, s[52:53]
    buffer_load_dwordx4 v2, s[24:27], s39 offen lds
    s_mov_b64 exec, -1
    v_exp_f32 v86, v86
    v_exp_f32 v87, v87
    v_exp_f32 v88, v88
    v_cvt_pk_bf16_f32 v178, v212, v213
    v_cvt_pk_bf16_f32 v179, v214, v215
    v_cvt_pk_bf16_f32 v180, v216, v217
    v_mfma_f32_4x4x4_16b_bf16 v[220:223], v[198:199], v[206:207], 0
    v_mfma_f32_32x32x16_bf16 v[112:127], v[140:143], v[28:31], v[112:127]
    ds_read_b64_tr_b16 v[148:149], v5 offset:17408
    ds_read_b64_tr_b16 v[150:151], v5 offset:17664
    s_add_u32 m0, s40, 0x4080
    s_mov_b64 exec, s[52:53]
    buffer_load_dwordx4 v2, s[24:27], s39 offen offset:896 lds
    s_mov_b64 exec, -1
    v_exp_f32 v89, v89
    v_exp_f32 v90, v90
    v_exp_f32 v91, v91
    v_exp_f32 v92, v92
    v_mfma_f32_4x4x4_16b_bf16 v[224:227], v[200:201], v[206:207], 0
    v_exp_f32 v93, v93
    v_smfmac_f32_32x32x32_bf16 v[48:63], v[160:163], v[80:87], v6
    v_mfma_f32_4x4x4_16b_bf16 v[228:231], v[202:203], v[206:207], 0
    v_exp_f32 v94, v94
    v_exp_f32 v95, v95
    v_cvt_pk_bf16_f32 v181, v218, v219
    v_cvt_pk_bf16_f32 v182, v220, v221
    v_exp_f32 v96, v96
    v_exp_f32 v97, v97
    v_smfmac_f32_32x32x32_bf16 v[48:63], v[164:167], v[88:95], v6
    s_setprio 3
    ds_read_b128 v[136:139], v4 offset:18432
    s_waitcnt lgkmcnt(5)
    v_exp_f32 v98, v98
    v_cvt_pk_bf16_f32 v183, v222, v223
    v_mfma_f32_4x4x4_16b_bf16 v[232:235], v[204:205], v[206:207], 0
    v_cvt_pk_bf16_f32 v184, v224, v225
    v_exp_f32 v99, v99
    v_exp_f32 v100, v100
    v_mfma_f32_32x32x16_bf16 v[64:79], v[128:131], v[16:19], 0
    s_setprio 2
    v_exp_f32 v101, v101
    ds_read_b128 v[140:143], v4 offset:19456
    ds_write_b128 v3, v[176:179] offset:32768
    v_exp_f32 v102, v102
    v_cvt_pk_bf16_f32 v185, v226, v227
    v_cvt_pk_bf16_f32 v186, v228, v229
    v_exp_f32 v103, v103
    v_exp_f32 v104, v104
    v_exp_f32 v105, v105
    v_mfma_f32_32x32x16_bf16 v[64:79], v[132:135], v[24:27], v[64:79]
    ds_read_b64_tr_b16 v[152:153], v5 offset:18432
    ds_write_b128 v3, v[180:183] offset:33280
    v_cvt_pk_bf16_f32 v187, v230, v231
    v_exp_f32 v106, v106
    v_cvt_pk_bf16_f32 v188, v232, v233
    v_exp_f32 v107, v107
    v_exp_f32 v108, v108
    v_exp_f32 v109, v109
    v_smfmac_f32_32x32x32_bf16 v[32:47], v[168:171], v[96:103], v6
    ds_read_b64_tr_b16 v[154:155], v5 offset:18688
    s_add_u32 s39, s39, 14336
    v_exp_f32 v110, v110
    v_cvt_pk_bf16_f32 v189, v234, v235
    v_exp_f32 v111, v111
    v_exp_f32 v112, v112
    v_exp_f32 v113, v113
    v_smfmac_f32_32x32x32_bf16 v[32:47], v[172:175], v[104:111], v6
    s_setprio 1
    ds_read_b64_tr_b16 v[156:157], v5 offset:19456
    ds_write_b128 v3, v[184:187] offset:33792
    v_exp_f32 v114, v114
    v_exp_f32 v115, v115
    v_exp_f32 v116, v116
    v_exp_f32 v117, v117
    v_mfma_f32_32x32x16_bf16 v[80:95], v[128:131], v[20:23], 0
    ds_write_b128 v3, v[188:191] offset:34304
    v_exp_f32 v118, v118
    v_exp_f32 v119, v119
    v_exp_f32 v120, v120
    v_exp_f32 v121, v121
    v_mfma_f32_32x32x16_bf16 v[80:95], v[132:135], v[28:31], v[80:95]
    ds_read_b64_tr_b16 v[158:159], v5 offset:19712
    v_exp_f32 v122, v122
    v_exp_f32 v123, v123
    v_smfmac_f32_32x32x32_bf16 v[48:63], v[168:171], v[112:119], v6
    s_setprio 0
    v_exp_f32 v124, v124
    v_exp_f32 v125, v125
    s_waitcnt vmcnt(0)
    ds_add_u32 v243, v246
    v_exp_f32 v126, v126
    v_exp_f32 v127, v127
    v_exp_f32 v64, v64
    v_exp_f32 v65, v65
    v_smfmac_f32_32x32x32_bf16 v[48:63], v[172:175], v[120:127], v6
    ds_read_b128 v[128:131], v4 offset:20480
    s_setprio 3
    s_waitcnt lgkmcnt(10)
    v_exp_f32 v66, v66
    v_exp_f32 v67, v67
    v_mfma_f32_32x32x16_bf16 v[96:111], v[136:139], v[16:19], 0
    v_exp_f32 v68, v68
    v_exp_f32 v69, v69
    ds_read_b128 v[132:135], v4 offset:21504
    v_exp_f32 v70, v70
    v_exp_f32 v71, v71
    v_exp_f32 v72, v72
    v_exp_f32 v73, v73
    v_mfma_f32_32x32x16_bf16 v[96:111], v[140:143], v[24:27], v[96:111]
    ds_read_b64_tr_b16 v[160:161], v5 offset:20480
    s_add_u32 m0, s40, 0x8000
    s_mov_b64 exec, s[52:53]
    buffer_load_dwordx4 v2, s[24:27], s39 offen lds
    s_mov_b64 exec, -1
    v_exp_f32 v74, v74
    v_exp_f32 v75, v75
    v_exp_f32 v76, v76
    v_exp_f32 v77, v77
    v_smfmac_f32_32x32x32_bf16 v[32:47], v[144:147], v[64:71], v6
    s_setprio 0
    s_add_u32 m0, s40, 0x8080
    s_mov_b64 exec, s[52:53]
    buffer_load_dwordx4 v2, s[24:27], s39 offen offset:896 lds
    s_mov_b64 exec, -1
    ds_read_b64_tr_b16 v[162:163], v5 offset:20736
    v_exp_f32 v78, v78
    v_exp_f32 v79, v79
    v_exp_f32 v80, v80
    v_exp_f32 v81, v81
    v_smfmac_f32_32x32x32_bf16 v[32:47], v[148:151], v[72:79], v6
    v_exp_f32 v82, v82
    v_exp_f32 v83, v83
    v_exp_f32 v84, v84
    v_exp_f32 v85, v85
    v_mfma_f32_32x32x16_bf16 v[112:127], v[136:139], v[20:23], 0
    ds_read_b64_tr_b16 v[164:165], v5 offset:21504
    ds_read_b64_tr_b16 v[166:167], v5 offset:21760
    v_exp_f32 v86, v86
    v_exp_f32 v87, v87
    v_exp_f32 v88, v88
    v_exp_f32 v89, v89
    v_exp_f32 v90, v90
    v_mfma_f32_32x32x16_bf16 v[112:127], v[140:143], v[28:31], v[112:127]
    v_exp_f32 v91, v91
    s_mov_b32 m0, s41
    s_nop 0
    buffer_load_dwordx4 v1, s[20:23], s38 offen offset:0 lds
    v_exp_f32 v92, v92
    v_exp_f32 v93, v93
    v_smfmac_f32_32x32x32_bf16 v[48:63], v[144:147], v[80:87], v6
    buffer_load_dwordx4 v1, s[20:23], s38 offen offset:1024 lds
    buffer_load_dwordx4 v1, s[20:23], s38 offen offset:2048 lds
    v_exp_f32 v94, v94
    v_exp_f32 v95, v95
    s_mov_b32 exec_hi, 0
    buffer_load_dwordx4 v1, s[20:23], s38 offen offset:3072 lds
    s_mov_b32 exec_hi, -1
    s_add_u32 s38, s38, 28672
    v_exp_f32 v96, v96
    v_exp_f32 v97, v97
    v_smfmac_f32_32x32x32_bf16 v[48:63], v[148:151], v[88:95], v6
    s_setprio 2
    s_waitcnt lgkmcnt(4)
    ds_read_b128 v[136:139], v4 offset:22528
    v_exp_f32 v98, v98
    v_exp_f32 v99, v99
    v_exp_f32 v100, v100
    v_exp_f32 v101, v101
    v_mfma_f32_32x32x16_bf16 v[64:79], v[128:131], v[16:19], 0
    ds_read_b128 v[140:143], v4 offset:23552
    v_exp_f32 v102, v102
    v_exp_f32 v103, v103
    v_exp_f32 v104, v104
    v_exp_f32 v105, v105
    v_mfma_f32_32x32x16_bf16 v[64:79], v[132:135], v[24:27], v[64:79]
    s_setprio 2
    ds_read_b64_tr_b16 v[168:169], v5 offset:22528
    v_exp_f32 v106, v106
    v_exp_f32 v107, v107
    v_exp_f32 v108, v108
    v_exp_f32 v109, v109
    v_smfmac_f32_32x32x32_bf16 v[32:47], v[152:155], v[96:103], v6
    ds_read_b64_tr_b16 v[170:171], v5 offset:22784
    v_exp_f32 v110, v110
    v_exp_f32 v111, v111
    v_exp_f32 v112, v112
    v_exp_f32 v113, v113
    v_smfmac_f32_32x32x32_bf16 v[32:47], v[156:159], v[104:111], v6
    ds_read_b64_tr_b16 v[172:173], v5 offset:23552
    v_exp_f32 v114, v114
    s_setprio 1
    v_exp_f32 v115, v115
    v_exp_f32 v116, v116
    v_exp_f32 v117, v117
    v_mfma_f32_32x32x16_bf16 v[80:95], v[128:131], v[20:23], 0
    ds_read_b64_tr_b16 v[174:175], v5 offset:23808
    v_exp_f32 v118, v118
    v_exp_f32 v119, v119
    v_exp_f32 v120, v120
    v_exp_f32 v121, v121
    s_setprio 0
    v_mfma_f32_32x32x16_bf16 v[80:95], v[132:135], v[28:31], v[80:95]
    ds_read_b32 v245, v244
    v_exp_f32 v122, v122
    v_exp_f32 v123, v123
    v_exp_f32 v124, v124
    v_exp_f32 v125, v125
    v_exp_f32 v126, v126
    v_exp_f32 v127, v127
    v_smfmac_f32_32x32x32_bf16 v[48:63], v[152:155], v[112:119], v6
    s_setprio 3
    v_exp_f32 v64, v64
    v_exp_f32 v65, v65
    v_smfmac_f32_32x32x32_bf16 v[48:63], v[156:159], v[120:127], v6
    s_waitcnt lgkmcnt(0)
    v_cmp_ge_u32 vcc, 1, v245
    s_cbranch_vccnz L_spinp1
L_backp1:
    ds_read_b128 v[128:131], v4 offset:32768
    v_exp_f32 v66, v66
    v_exp_f32 v67, v67
    v_exp_f32 v68, v68
    v_exp_f32 v69, v69
    v_mfma_f32_32x32x16_bf16 v[96:111], v[136:139], v[16:19], 0
    ds_read_b128 v[132:135], v4 offset:33792
    v_exp_f32 v70, v70
    v_exp_f32 v71, v71
    v_exp_f32 v72, v72
    v_exp_f32 v73, v73
    v_mfma_f32_32x32x16_bf16 v[96:111], v[140:143], v[24:27], v[96:111]
    ds_read_b64_tr_b16 v[144:145], v5 offset:32768
    ds_read_b64_tr_b16 v[146:147], v5 offset:33024
    v_exp_f32 v74, v74
    v_exp_f32 v75, v75
    v_exp_f32 v76, v76
    v_exp_f32 v77, v77
    v_smfmac_f32_32x32x32_bf16 v[32:47], v[160:163], v[64:71], v6
    v_exp_f32 v78, v78
    v_exp_f32 v79, v79
    v_exp_f32 v80, v80
    v_exp_f32 v81, v81
    v_smfmac_f32_32x32x32_bf16 v[32:47], v[164:167], v[72:79], v6
    ds_read_b64_tr_b16 v[148:149], v5 offset:33792
    v_exp_f32 v82, v82
    v_exp_f32 v83, v83
    v_exp_f32 v84, v84
    ds_read_b64_tr_b16 v[150:151], v5 offset:34048
    v_exp_f32 v85, v85
    v_mfma_f32_32x32x16_bf16 v[112:127], v[136:139], v[20:23], 0
    v_exp_f32 v86, v86
    v_exp_f32 v87, v87
    v_exp_f32 v88, v88
    v_mfma_f32_32x32x16_bf16 v[112:127], v[140:143], v[28:31], v[112:127]
    v_exp_f32 v89, v89
    v_exp_f32 v90, v90
    v_exp_f32 v91, v91
    v_exp_f32 v92, v92
    v_exp_f32 v93, v93
    v_smfmac_f32_32x32x32_bf16 v[48:63], v[160:163], v[80:87], v6
    v_exp_f32 v94, v94
    v_exp_f32 v95, v95
    v_exp_f32 v96, v96
    v_exp_f32 v97, v97
    v_smfmac_f32_32x32x32_bf16 v[48:63], v[164:167], v[88:95], v6
    s_waitcnt lgkmcnt(4)
    ds_read_b128 v[136:139], v4 offset:34816
    s_setprio 2
    v_exp_f32 v98, v98
    v_exp_f32 v99, v99
    v_exp_f32 v100, v100
    v_exp_f32 v101, v101
    v_mfma_f32_32x32x16_bf16 v[64:79], v[128:131], v[16:19], 0
    v_exp_f32 v102, v102
    v_exp_f32 v103, v103
    v_exp_f32 v104, v104
    v_exp_f32 v105, v105
    ds_read_b128 v[140:143], v4 offset:35840
    v_mfma_f32_32x32x16_bf16 v[64:79], v[132:135], v[24:27], v[64:79]
    ds_read_b64_tr_b16 v[152:153], v5 offset:34816
    v_exp_f32 v106, v106
    v_exp_f32 v107, v107
    v_exp_f32 v108, v108
    v_exp_f32 v109, v109
    s_add_u32 s39, s39, 14336
    v_smfmac_f32_32x32x32_bf16 v[32:47], v[168:171], v[96:103], v6
    ds_read_b64_tr_b16 v[154:155], v5 offset:35072
    v_exp_f32 v110, v110
    v_exp_f32 v111, v111
    v_exp_f32 v112, v112
    ds_read_b64_tr_b16 v[156:157], v5 offset:35840
    v_exp_f32 v113, v113
    s_setprio 1
    v_exp_f32 v114, v114
    v_exp_f32 v115, v115
    v_exp_f32 v116, v116
    v_smfmac_f32_32x32x32_bf16 v[32:47], v[172:175], v[104:111], v6
    v_exp_f32 v117, v117
    v_mfma_f32_32x32x16_bf16 v[80:95], v[128:131], v[20:23], 0
    v_exp_f32 v118, v118
    v_exp_f32 v119, v119
    v_exp_f32 v120, v120
    v_exp_f32 v121, v121
    s_setprio 0
    v_mfma_f32_32x32x16_bf16 v[80:95], v[132:135], v[28:31], v[80:95]
    s_waitcnt vmcnt(0)
    ds_read_b64_tr_b16 v[158:159], v5 offset:36096
    v_exp_f32 v122, v122
    v_exp_f32 v123, v123
    v_exp_f32 v124, v124
    v_exp_f32 v125, v125
    v_smfmac_f32_32x32x32_bf16 v[48:63], v[168:171], v[112:119], v6
    ds_add_u32 v243, v246
    v_exp_f32 v126, v126
    v_exp_f32 v127, v127
    v_exp_f32 v64, v64
    v_exp_f32 v65, v65
    v_smfmac_f32_32x32x32_bf16 v[48:63], v[172:175], v[120:127], v6
    ds_read_b128 v[128:131], v4 offset:36864
    s_waitcnt lgkmcnt(6)
    v_exp_f32 v66, v66
    v_exp_f32 v67, v67
    v_exp_f32 v68, v68
    ds_read_b128 v[132:135], v4 offset:37888
    v_exp_f32 v69, v69
    v_mfma_f32_32x32x16_bf16 v[96:111], v[136:139], v[16:19], 0
    v_exp_f32 v70, v70
    v_exp_f32 v71, v71
    v_exp_f32 v72, v72
    v_exp_f32 v73, v73
    v_mfma_f32_32x32x16_bf16 v[96:111], v[140:143], v[24:27], v[96:111]
    ds_read_b64_tr_b16 v[160:161], v5 offset:36864
    v_exp_f32 v74, v74
    v_exp_f32 v75, v75
    s_add_u32 m0, s40, 0xffffc000
    s_mov_b64 exec, s[52:53]
    buffer_load_dwordx4 v2, s[24:27], s39 offen lds
    s_mov_b64 exec, -1
    v_exp_f32 v76, v76
    v_exp_f32 v77, v77
    v_smfmac_f32_32x32x32_bf16 v[32:47], v[144:147], v[64:71], v6
    s_setprio 3
    ds_read_b64_tr_b16 v[162:163], v5 offset:37120
    v_exp_f32 v78, v78
    s_add_u32 m0, s40, 0xffffc080
    s_mov_b64 exec, s[52:53]
    buffer_load_dwordx4 v2, s[24:27], s39 offen offset:896 lds
    s_mov_b64 exec, -1
    v_exp_f32 v79, v79
    v_exp_f32 v80, v80
    v_exp_f32 v81, v81
    v_smfmac_f32_32x32x32_bf16 v[32:47], v[148:151], v[72:79], v6
    ds_read_b64_tr_b16 v[164:165], v5 offset:37888
    ds_read2_b64 v[176:179], v8 offset0:0 offset1:1
    v_exp_f32 v82, v82
    v_exp_f32 v83, v83
    v_exp_f32 v84, v84
    v_mfma_f32_32x32x16_bf16 v[112:127], v[136:139], v[20:23], 0
    v_exp_f32 v85, v85
    ds_read2_b64 v[180:183], v8 offset0:2 offset1:3
    ds_read_b64_tr_b16 v[166:167], v5 offset:38144
    v_exp_f32 v86, v86
    v_exp_f32 v87, v87
    v_exp_f32 v88, v88
    v_mfma_f32_32x32x16_bf16 v[112:127], v[140:143], v[28:31], v[112:127]
    v_exp_f32 v89, v89
    ds_read2_b64 v[184:187], v8 offset0:4 offset1:5
    v_exp_f32 v90, v90
    v_exp_f32 v91, v91
    v_exp_f32 v92, v92
    v_exp_f32 v93, v93
    v_smfmac_f32_32x32x32_bf16 v[48:63], v[144:147], v[80:87], v6
    ds_read_b64 v[188:189], v8 offset:48
    v_exp_f32 v94, v94
    v_exp_f32 v95, v95
    v_exp_f32 v96, v96
    v_exp_f32 v97, v97
    v_smfmac_f32_32x32x32_bf16 v[48:63], v[148:151], v[88:95], v6
    s_setprio 2
    ds_read_b128 v[136:139], v4 offset:38912
    s_waitcnt lgkmcnt(1)
    ds_read_b64_tr_b16 v[192:193], v9 offset:0
    v_exp_f32 v98, v98
    v_exp_f32 v99, v99
    v_exp_f32 v100, v100
    v_mfma_f32_4x4x4_16b_bf16 v[208:211], v[176:177], v[176:177], 0
    v_exp_f32 v101, v101
    v_mfma_f32_32x32x16_bf16 v[64:79], v[128:131], v[16:19], 0
    ds_read_b128 v[140:143], v4 offset:39936
    ds_read_b64_tr_b16 v[194:195], v9 offset:8
    v_exp_f32 v102, v102
    v_exp_f32 v103, v103
    v_exp_f32 v104, v104
    v_mfma_f32_4x4x4_16b_bf16 v[208:211], v[178:179], v[178:179], v[208:211]
    v_exp_f32 v105, v105
    v_mfma_f32_32x32x16_bf16 v[64:79], v[132:135], v[24:27], v[64:79]
    s_setprio 2
    ds_read_b64_tr_b16 v[168:169], v5 offset:38912
    ds_read_b64_tr_b16 v[196:197], v9 offset:16
    v_exp_f32 v106, v106
    v_exp_f32 v107, v107
    v_exp_f32 v108, v108
    v_mfma_f32_4x4x4_16b_bf16 v[208:211], v[180:181], v[180:181], v[208:211]
    v_exp_f32 v109, v109
    v_smfmac_f32_32x32x32_bf16 v[32:47], v[152:155], v[96:103], v6
    ds_read_b64_tr_b16 v[170:171], v5 offset:39168
    ds_read_b64_tr_b16 v[198:199], v9 offset:24
    v_exp_f32 v110, v110
    v_exp_f32 v111, v111
    v_mfma_f32_4x4x4_16b_bf16 v[208:211], v[182:183], v[182:183], v[208:211]
    v_exp_f32 v112, v112
    v_exp_f32 v113, v113
    v_smfmac_f32_32x32x32_bf16 v[32:47], v[156:159], v[104:111], v6
    s_setprio 1
    ds_read_b64_tr_b16 v[172:173], v5 offset:39936
    v_exp_f32 v114, v114
    v_exp_f32 v115, v115
    v_exp_f32 v116, v116
    v_mfma_f32_4x4x4_16b_bf16 v[208:211], v[184:185], v[184:185], v[208:211]
    v_exp_f32 v117, v117
    v_mfma_f32_32x32x16_bf16 v[80:95], v[128:131], v[20:23], 0
    ds_read_b64_tr_b16 v[200:201], v9 offset:32
    ds_read_b64_tr_b16 v[202:203], v9 offset:40
    v_exp_f32 v118, v118
    v_exp_f32 v119, v119
    v_exp_f32 v120, v120
    v_mfma_f32_4x4x4_16b_bf16 v[208:211], v[186:187], v[186:187], v[208:211]
    v_exp_f32 v121, v121
    v_mfma_f32_32x32x16_bf16 v[80:95], v[132:135], v[28:31], v[80:95]
    ds_read_b64_tr_b16 v[174:175], v5 offset:40192
    s_setprio 0
    ds_read_b32 v245, v244
    ds_read_b64_tr_b16 v[204:205], v9 offset:48
    v_exp_f32 v122, v122
    v_exp_f32 v123, v123
    v_mfma_f32_4x4x4_16b_bf16 v[208:211], v[188:189], v[188:189], v[208:211]
    v_exp_f32 v124, v124
    v_exp_f32 v125, v125
    v_exp_f32 v126, v126
    v_smfmac_f32_32x32x32_bf16 v[48:63], v[152:155], v[112:119], v6
    v_exp_f32 v127, v127
    v_exp_f32 v64, v64
    s_waitcnt lgkmcnt(1)
    v_exp_f32 v65, v65
    v_smfmac_f32_32x32x32_bf16 v[48:63], v[156:159], v[120:127], v6
    s_setprio 3
    v_cmp_ge_u32 vcc, 2, v245
    s_cbranch_vccnz L_spinp2
L_backp2:
    ds_read_b128 v[128:131], v4 offset:49152
    v_exp_f32 v66, v66
    v_exp_f32 v67, v67
    v_cndmask_b32 v14, v208, v209, s[64:65]
    v_exp_f32 v68, v68
    ds_read_b128 v[132:135], v4 offset:50176
    v_cndmask_b32 v14, v14, v210, s[66:67]
    v_cndmask_b32 v14, v14, v211, s[68:69]
    v_exp_f32 v69, v69
    v_sqrt_f32 v14, v14
    v_exp_f32 v70, v70
    v_add_f32 v14, s44, v14
    v_mfma_f32_32x32x16_bf16 v[96:111], v[136:139], v[16:19], 0
    v_exp_f32 v71, v71
    v_exp_f32 v72, v72
    v_rcp_f32 v15, v14
    v_exp_f32 v73, v73
    v_mfma_f32_32x32x16_bf16 v[96:111], v[140:143], v[24:27], v[96:111]
    ds_read_b64_tr_b16 v[144:145], v5 offset:49152
    v_exp_f32 v74, v74
    v_cvt_pk_bf16_f32 v15, v15, v15
    v_and_b32 v206, v15, v10
    v_and_b32 v207, v15, v11
    v_exp_f32 v75, v75
    v_exp_f32 v76, v76
    v_mfma_f32_4x4x4_16b_bf16 v[208:211], v[192:193], v[206:207], 0
    v_exp_f32 v77, v77
    v_smfmac_f32_32x32x32_bf16 v[32:47], v[160:163], v[64:71], v6
    ds_read_b64_tr_b16 v[146:147], v5 offset:49408
    v_exp_f32 v78, v78
    v_exp_f32 v79, v79
    v_exp_f32 v80, v80
    v_mfma_f32_4x4x4_16b_bf16 v[212:215], v[194:195], v[206:207], 0
    v_exp_f32 v81, v81
    v_mfma_f32_4x4x4_16b_bf16 v[216:219], v[196:197], v[206:207], 0
    v_smfmac_f32_32x32x32_bf16 v[32:47], v[164:167], v[72:79], v6
    ds_read_b64_tr_b16 v[148:149], v5 offset:50176
    v_exp_f32 v82, v82
    v_exp_f32 v83, v83
    v_cvt_pk_bf16_f32 v176, v208, v209
    v_exp_f32 v84, v84
    v_cvt_pk_bf16_f32 v177, v210, v211
    v_exp_f32 v85, v85
    v_mfma_f32_32x32x16_bf16 v[112:127], v[136:139], v[20:23], 0
    ds_read_b64_tr_b16 v[150:151], v5 offset:50432
    v_exp_f32 v86, v86
    v_exp_f32 v87, v87
    v_exp_f32 v88, v88
    v_cvt_pk_bf16_f32 v178, v212, v213
    v_cvt_pk_bf16_f32 v179, v214, v215
    v_cvt_pk_bf16_f32 v180, v216, v217
    v_mfma_f32_4x4x4_16b_bf16 v[220:223], v[198:199], v[206:207], 0
    v_mfma_f32_32x32x16_bf16 v[112:127], v[140:143], v[28:31], v[112:127]
    v_exp_f32 v89, v89
    v_exp_f32 v90, v90
    v_exp_f32 v91, v91
    v_exp_f32 v92, v92
    v_mfma_f32_4x4x4_16b_bf16 v[224:227], v[200:201], v[206:207], 0
    v_exp_f32 v93, v93
    v_smfmac_f32_32x32x32_bf16 v[48:63], v[160:163], v[80:87], v6
    v_exp_f32 v94, v94
    v_exp_f32 v95, v95
    v_cvt_pk_bf16_f32 v181, v218, v219
    v_cvt_pk_bf16_f32 v182, v220, v221
    v_exp_f32 v96, v96
    v_mfma_f32_4x4x4_16b_bf16 v[228:231], v[202:203], v[206:207], 0
    v_exp_f32 v97, v97
    v_smfmac_f32_32x32x32_bf16 v[48:63], v[164:167], v[88:95], v6
    s_setprio 2
    ds_read_b128 v[136:139], v4 offset:51200
    s_waitcnt lgkmcnt(5)
    v_exp_f32 v98, v98
    v_cvt_pk_bf16_f32 v183, v222, v223
    v_mfma_f32_4x4x4_16b_bf16 v[232:235], v[204:205], v[206:207], 0
    v_cvt_pk_bf16_f32 v184, v224, v225
    v_exp_f32 v99, v99
    v_exp_f32 v100, v100
    v_mfma_f32_32x32x16_bf16 v[64:79], v[128:131], v[16:19], 0
    v_exp_f32 v101, v101
    ds_read_b128 v[140:143], v4 offset:52224
    ds_write_b128 v3, v[176:179] offset:0
    v_exp_f32 v102, v102
    v_cvt_pk_bf16_f32 v185, v226, v227
    v_cvt_pk_bf16_f32 v186, v228, v229
    v_exp_f32 v103, v103
    v_exp_f32 v104, v104
    v_exp_f32 v105, v105
    v_mfma_f32_32x32x16_bf16 v[64:79], v[132:135], v[24:27], v[64:79]
    ds_read_b64_tr_b16 v[152:153], v5 offset:51200
    ds_write_b128 v3, v[180:183] offset:512
    v_cvt_pk_bf16_f32 v187, v230, v231
    v_exp_f32 v106, v106
    v_cvt_pk_bf16_f32 v188, v232, v233
    v_exp_f32 v107, v107
    v_exp_f32 v108, v108
    v_exp_f32 v109, v109
    v_smfmac_f32_32x32x32_bf16 v[32:47], v[168:171], v[96:103], v6
    ds_read_b64_tr_b16 v[154:155], v5 offset:51456
    s_add_u32 s39, s39, 14336
    v_exp_f32 v110, v110
    v_cvt_pk_bf16_f32 v189, v234, v235
    v_exp_f32 v111, v111
    v_exp_f32 v112, v112
    v_exp_f32 v113, v113
    v_smfmac_f32_32x32x32_bf16 v[32:47], v[172:175], v[104:111], v6
    s_setprio 1
    ds_read_b64_tr_b16 v[156:157], v5 offset:52224
    ds_write_b128 v3, v[184:187] offset:1024
    v_exp_f32 v114, v114
    v_exp_f32 v115, v115
    v_exp_f32 v116, v116
    v_exp_f32 v117, v117
    v_mfma_f32_32x32x16_bf16 v[80:95], v[128:131], v[20:23], 0
    ds_write_b128 v3, v[188:191] offset:1536
    v_exp_f32 v118, v118
    v_exp_f32 v119, v119
    v_exp_f32 v120, v120
    v_exp_f32 v121, v121
    v_mfma_f32_32x32x16_bf16 v[80:95], v[132:135], v[28:31], v[80:95]
    ds_read_b64_tr_b16 v[158:159], v5 offset:52480
    v_exp_f32 v122, v122
    v_exp_f32 v123, v123
    v_smfmac_f32_32x32x32_bf16 v[48:63], v[168:171], v[112:119], v6
    s_setprio 0
    v_exp_f32 v124, v124
    v_exp_f32 v125, v125
    s_waitcnt vmcnt(0)
    ds_add_u32 v243, v246
    v_exp_f32 v126, v126
    v_exp_f32 v127, v127
    v_exp_f32 v64, v64
    v_exp_f32 v65, v65
    v_smfmac_f32_32x32x32_bf16 v[48:63], v[172:175], v[120:127], v6
    ds_read_b128 v[128:131], v4 offset:53248
    s_setprio 3
    s_waitcnt lgkmcnt(10)
    v_exp_f32 v66, v66
    v_exp_f32 v67, v67
    v_mfma_f32_32x32x16_bf16 v[96:111], v[136:139], v[16:19], 0
    v_exp_f32 v68, v68
    v_exp_f32 v69, v69
    ds_read_b128 v[132:135], v4 offset:54272
    v_exp_f32 v70, v70
    v_exp_f32 v71, v71
    v_exp_f32 v72, v72
    v_exp_f32 v73, v73
    v_mfma_f32_32x32x16_bf16 v[96:111], v[140:143], v[24:27], v[96:111]
    ds_read_b64_tr_b16 v[160:161], v5 offset:53248
    s_add_u32 m0, s40, 0x0
    s_mov_b64 exec, s[52:53]
    buffer_load_dwordx4 v2, s[24:27], s39 offen lds
    s_mov_b64 exec, -1
    v_exp_f32 v74, v74
    v_exp_f32 v75, v75
    v_exp_f32 v76, v76
    v_exp_f32 v77, v77
    v_smfmac_f32_32x32x32_bf16 v[32:47], v[144:147], v[64:71], v6
    s_setprio 0
    s_add_u32 m0, s40, 0x80
    s_mov_b64 exec, s[52:53]
    buffer_load_dwordx4 v2, s[24:27], s39 offen offset:896 lds
    s_mov_b64 exec, -1
    ds_read_b64_tr_b16 v[162:163], v5 offset:53504
    v_exp_f32 v78, v78
    v_exp_f32 v79, v79
    v_exp_f32 v80, v80
    v_exp_f32 v81, v81
    v_smfmac_f32_32x32x32_bf16 v[32:47], v[148:151], v[72:79], v6
    v_exp_f32 v82, v82
    v_exp_f32 v83, v83
    v_exp_f32 v84, v84
    v_exp_f32 v85, v85
    v_mfma_f32_32x32x16_bf16 v[112:127], v[136:139], v[20:23], 0
    ds_read_b64_tr_b16 v[164:165], v5 offset:54272
    ds_read_b64_tr_b16 v[166:167], v5 offset:54528
    v_exp_f32 v86, v86
    v_exp_f32 v87, v87
    v_exp_f32 v88, v88
    v_exp_f32 v89, v89
    v_exp_f32 v90, v90
    v_mfma_f32_32x32x16_bf16 v[112:127], v[140:143], v[28:31], v[112:127]
    v_exp_f32 v91, v91
    s_mov_b32 m0, s41
    s_nop 0
    buffer_load_dwordx4 v1, s[20:23], s38 offen offset:0 lds
    v_exp_f32 v92, v92
    v_exp_f32 v93, v93
    v_smfmac_f32_32x32x32_bf16 v[48:63], v[144:147], v[80:87], v6
    buffer_load_dwordx4 v1, s[20:23], s38 offen offset:1024 lds
    buffer_load_dwordx4 v1, s[20:23], s38 offen offset:2048 lds
    v_exp_f32 v94, v94
    v_exp_f32 v95, v95
    s_mov_b32 exec_hi, 0
    buffer_load_dwordx4 v1, s[20:23], s38 offen offset:3072 lds
    s_mov_b32 exec_hi, -1
    s_add_u32 s38, s38, 28672
    v_exp_f32 v96, v96
    v_exp_f32 v97, v97
    v_smfmac_f32_32x32x32_bf16 v[48:63], v[148:151], v[88:95], v6
    s_setprio 2
    s_waitcnt lgkmcnt(4)
    ds_read_b128 v[136:139], v4 offset:55296
    v_exp_f32 v98, v98
    v_exp_f32 v99, v99
    v_exp_f32 v100, v100
    v_exp_f32 v101, v101
    v_mfma_f32_32x32x16_bf16 v[64:79], v[128:131], v[16:19], 0
    ds_read_b128 v[140:143], v4 offset:56320
    v_exp_f32 v102, v102
    v_exp_f32 v103, v103
    v_exp_f32 v104, v104
    v_exp_f32 v105, v105
    v_mfma_f32_32x32x16_bf16 v[64:79], v[132:135], v[24:27], v[64:79]
    s_setprio 2
    ds_read_b64_tr_b16 v[168:169], v5 offset:55296
    v_exp_f32 v106, v106
    v_exp_f32 v107, v107
    v_exp_f32 v108, v108
    v_exp_f32 v109, v109
    v_smfmac_f32_32x32x32_bf16 v[32:47], v[152:155], v[96:103], v6
    ds_read_b64_tr_b16 v[170:171], v5 offset:55552
    v_exp_f32 v110, v110
    v_exp_f32 v111, v111
    v_exp_f32 v112, v112
    v_exp_f32 v113, v113
    v_smfmac_f32_32x32x32_bf16 v[32:47], v[156:159], v[104:111], v6
    ds_read_b64_tr_b16 v[172:173], v5 offset:56320
    v_exp_f32 v114, v114
    s_setprio 1
    v_exp_f32 v115, v115
    v_exp_f32 v116, v116
    v_exp_f32 v117, v117
    v_mfma_f32_32x32x16_bf16 v[80:95], v[128:131], v[20:23], 0
    ds_read_b64_tr_b16 v[174:175], v5 offset:56576
    v_exp_f32 v118, v118
    v_exp_f32 v119, v119
    v_exp_f32 v120, v120
    v_exp_f32 v121, v121
    s_setprio 0
    v_mfma_f32_32x32x16_bf16 v[80:95], v[132:135], v[28:31], v[80:95]
    ds_read_b32 v245, v244
    v_exp_f32 v122, v122
    v_exp_f32 v123, v123
    v_exp_f32 v124, v124
    v_exp_f32 v125, v125
    v_exp_f32 v126, v126
    v_exp_f32 v127, v127
    v_smfmac_f32_32x32x32_bf16 v[48:63], v[152:155], v[112:119], v6
    s_setprio 3
    v_exp_f32 v64, v64
    v_exp_f32 v65, v65
    v_smfmac_f32_32x32x32_bf16 v[48:63], v[156:159], v[120:127], v6
    s_waitcnt lgkmcnt(0)
    v_cmp_ge_u32 vcc, 3, v245
    s_cbranch_vccnz L_spinp3
L_backp3:
    ds_read_b128 v[128:131], v4 offset:0
    v_exp_f32 v66, v66
    v_exp_f32 v67, v67
    v_exp_f32 v68, v68
    v_exp_f32 v69, v69
    v_mfma_f32_32x32x16_bf16 v[96:111], v[136:139], v[16:19], 0
    ds_read_b128 v[132:135], v4 offset:1024
    v_exp_f32 v70, v70
    v_exp_f32 v71, v71
    v_exp_f32 v72, v72
    v_exp_f32 v73, v73
    v_mfma_f32_32x32x16_bf16 v[96:111], v[140:143], v[24:27], v[96:111]
    ds_read_b64_tr_b16 v[144:145], v5 offset:0
    ds_read_b64_tr_b16 v[146:147], v5 offset:256
    v_exp_f32 v74, v74
    v_exp_f32 v75, v75
    v_exp_f32 v76, v76
    v_exp_f32 v77, v77
    v_smfmac_f32_32x32x32_bf16 v[32:47], v[160:163], v[64:71], v6
    v_exp_f32 v78, v78
    v_exp_f32 v79, v79
    v_exp_f32 v80, v80
    v_exp_f32 v81, v81
    v_smfmac_f32_32x32x32_bf16 v[32:47], v[164:167], v[72:79], v6
    ds_read_b64_tr_b16 v[148:149], v5 offset:1024
    v_exp_f32 v82, v82
    v_exp_f32 v83, v83
    v_exp_f32 v84, v84
    ds_read_b64_tr_b16 v[150:151], v5 offset:1280
    v_exp_f32 v85, v85
    v_mfma_f32_32x32x16_bf16 v[112:127], v[136:139], v[20:23], 0
    v_exp_f32 v86, v86
    v_exp_f32 v87, v87
    v_exp_f32 v88, v88
    v_mfma_f32_32x32x16_bf16 v[112:127], v[140:143], v[28:31], v[112:127]
    v_exp_f32 v89, v89
    v_exp_f32 v90, v90
    v_exp_f32 v91, v91
    v_exp_f32 v92, v92
    v_exp_f32 v93, v93
    v_smfmac_f32_32x32x32_bf16 v[48:63], v[160:163], v[80:87], v6
    v_exp_f32 v94, v94
    v_exp_f32 v95, v95
    v_exp_f32 v96, v96
    v_exp_f32 v97, v97
    v_smfmac_f32_32x32x32_bf16 v[48:63], v[164:167], v[88:95], v6
    s_waitcnt lgkmcnt(4)
    ds_read_b128 v[136:139], v4 offset:2048
    s_setprio 2
    v_exp_f32 v98, v98
    v_exp_f32 v99, v99
    v_exp_f32 v100, v100
    v_exp_f32 v101, v101
    v_mfma_f32_32x32x16_bf16 v[64:79], v[128:131], v[16:19], 0
    v_exp_f32 v102, v102
    v_exp_f32 v103, v103
    v_exp_f32 v104, v104
    v_exp_f32 v105, v105
    ds_read_b128 v[140:143], v4 offset:3072
    v_mfma_f32_32x32x16_bf16 v[64:79], v[132:135], v[24:27], v[64:79]
    ds_read_b64_tr_b16 v[152:153], v5 offset:2048
    v_exp_f32 v106, v106
    v_exp_f32 v107, v107
    v_exp_f32 v108, v108
    v_exp_f32 v109, v109
    s_add_u32 s39, s39, 14336
    v_smfmac_f32_32x32x32_bf16 v[32:47], v[168:171], v[96:103], v6
    ds_read_b64_tr_b16 v[154:155], v5 offset:2304
    v_exp_f32 v110, v110
    v_exp_f32 v111, v111
    v_exp_f32 v112, v112
    ds_read_b64_tr_b16 v[156:157], v5 offset:3072
    v_exp_f32 v113, v113
    s_setprio 1
    v_exp_f32 v114, v114
    v_exp_f32 v115, v115
    v_exp_f32 v116, v116
    v_smfmac_f32_32x32x32_bf16 v[32:47], v[172:175], v[104:111], v6
    v_exp_f32 v117, v117
    v_mfma_f32_32x32x16_bf16 v[80:95], v[128:131], v[20:23], 0
    v_exp_f32 v118, v118
    v_exp_f32 v119, v119
    v_exp_f32 v120, v120
    v_exp_f32 v121, v121
    s_setprio 0
    v_mfma_f32_32x32x16_bf16 v[80:95], v[132:135], v[28:31], v[80:95]
    s_waitcnt vmcnt(0)
    ds_read_b64_tr_b16 v[158:159], v5 offset:3328
    v_exp_f32 v122, v122
    v_exp_f32 v123, v123
    v_exp_f32 v124, v124
    v_exp_f32 v125, v125
    v_smfmac_f32_32x32x32_bf16 v[48:63], v[168:171], v[112:119], v6
    ds_add_u32 v243, v246
    v_exp_f32 v126, v126
    v_exp_f32 v127, v127
    v_exp_f32 v64, v64
    v_exp_f32 v65, v65
    v_smfmac_f32_32x32x32_bf16 v[48:63], v[172:175], v[120:127], v6
    ds_read_b128 v[128:131], v4 offset:4096
    s_setprio 3
    s_waitcnt lgkmcnt(6)
    v_exp_f32 v66, v66
    v_exp_f32 v67, v67
    v_exp_f32 v68, v68
    ds_read_b128 v[132:135], v4 offset:5120
    v_exp_f32 v69, v69
    v_mfma_f32_32x32x16_bf16 v[96:111], v[136:139], v[16:19], 0
    v_exp_f32 v70, v70
    v_exp_f32 v71, v71
    v_exp_f32 v72, v72
    v_exp_f32 v73, v73
    v_mfma_f32_32x32x16_bf16 v[96:111], v[140:143], v[24:27], v[96:111]
    ds_read_b64_tr_b16 v[160:161], v5 offset:4096
    v_exp_f32 v74, v74
    v_exp_f32 v75, v75
    s_add_u32 m0, s40, 0x4000
    s_mov_b64 exec, s[52:53]
    buffer_load_dwordx4 v2, s[24:27], s39 offen lds
    s_mov_b64 exec, -1
    v_exp_f32 v76, v76
    v_exp_f32 v77, v77
    v_smfmac_f32_32x32x32_bf16 v[32:47], v[144:147], v[64:71], v6
    s_setprio 0
    ds_read_b64_tr_b16 v[162:163], v5 offset:4352
    v_exp_f32 v78, v78
    s_add_u32 m0, s40, 0x4080
    s_mov_b64 exec, s[52:53]
    buffer_load_dwordx4 v2, s[24:27], s39 offen offset:896 lds
    s_mov_b64 exec, -1
    v_exp_f32 v79, v79
    v_exp_f32 v80, v80
    v_exp_f32 v81, v81
    v_smfmac_f32_32x32x32_bf16 v[32:47], v[148:151], v[72:79], v6
    ds_read_b64_tr_b16 v[164:165], v5 offset:5120
    ds_read2_b64 v[176:179], v8 offset0:0 offset1:1
    v_exp_f32 v82, v82
    v_exp_f32 v83, v83
    v_exp_f32 v84, v84
    v_mfma_f32_32x32x16_bf16 v[112:127], v[136:139], v[20:23], 0
    v_exp_f32 v85, v85
    ds_read2_b64 v[180:183], v8 offset0:2 offset1:3
    ds_read_b64_tr_b16 v[166:167], v5 offset:5376
    v_exp_f32 v86, v86
    v_exp_f32 v87, v87
    v_exp_f32 v88, v88
    v_mfma_f32_32x32x16_bf16 v[112:127], v[140:143], v[28:31], v[112:127]
    v_exp_f32 v89, v89
    ds_read2_b64 v[184:187], v8 offset0:4 offset1:5
    v_exp_f32 v90, v90
    v_exp_f32 v91, v91
    v_exp_f32 v92, v92
    v_exp_f32 v93, v93
    v_smfmac_f32_32x32x32_bf16 v[48:63], v[144:147], v[80:87], v6
    ds_read_b64 v[188:189], v8 offset:48
    v_exp_f32 v94, v94
    v_exp_f32 v95, v95
    v_exp_f32 v96, v96
    v_exp_f32 v97, v97
    v_smfmac_f32_32x32x32_bf16 v[48:63], v[148:151], v[88:95], v6
    s_setprio 2
    ds_read_b128 v[136:139], v4 offset:6144
    s_waitcnt lgkmcnt(1)
    ds_read_b64_tr_b16 v[192:193], v9 offset:0
    v_exp_f32 v98, v98
    v_exp_f32 v99, v99
    v_exp_f32 v100, v100
    v_mfma_f32_4x4x4_16b_bf16 v[208:211], v[176:177], v[176:177], 0
    v_exp_f32 v101, v101
    v_mfma_f32_32x32x16_bf16 v[64:79], v[128:131], v[16:19], 0
    ds_read_b128 v[140:143], v4 offset:7168
    ds_read_b64_tr_b16 v[194:195], v9 offset:8
    v_exp_f32 v102, v102
    v_exp_f32 v103, v103
    v_exp_f32 v104, v104
    v_mfma_f32_4x4x4_16b_bf16 v[208:211], v[178:179], v[178:179], v[208:211]
    v_exp_f32 v105, v105
    v_mfma_f32_32x32x16_bf16 v[64:79], v[132:135], v[24:27], v[64:79]
    s_setprio 2
    ds_read_b64_tr_b16 v[168:169], v5 offset:6144
    ds_read_b64_tr_b16 v[196:197], v9 offset:16
    v_exp_f32 v106, v106
    v_exp_f32 v107, v107
    v_exp_f32 v108, v108
    v_mfma_f32_4x4x4_16b_bf16 v[208:211], v[180:181], v[180:181], v[208:211]
    v_exp_f32 v109, v109
    v_smfmac_f32_32x32x32_bf16 v[32:47], v[152:155], v[96:103], v6
    ds_read_b64_tr_b16 v[170:171], v5 offset:6400
    ds_read_b64_tr_b16 v[198:199], v9 offset:24
    v_exp_f32 v110, v110
    v_exp_f32 v111, v111
    v_mfma_f32_4x4x4_16b_bf16 v[208:211], v[182:183], v[182:183], v[208:211]
    v_exp_f32 v112, v112
    v_exp_f32 v113, v113
    v_smfmac_f32_32x32x32_bf16 v[32:47], v[156:159], v[104:111], v6
    s_setprio 1
    ds_read_b64_tr_b16 v[172:173], v5 offset:7168
    v_exp_f32 v114, v114
    v_exp_f32 v115, v115
    v_exp_f32 v116, v116
    v_mfma_f32_4x4x4_16b_bf16 v[208:211], v[184:185], v[184:185], v[208:211]
    v_exp_f32 v117, v117
    v_mfma_f32_32x32x16_bf16 v[80:95], v[128:131], v[20:23], 0
    ds_read_b64_tr_b16 v[200:201], v9 offset:32
    ds_read_b64_tr_b16 v[202:203], v9 offset:40
    v_exp_f32 v118, v118
    v_exp_f32 v119, v119
    v_exp_f32 v120, v120
    v_mfma_f32_4x4x4_16b_bf16 v[208:211], v[186:187], v[186:187], v[208:211]
    v_exp_f32 v121, v121
    v_mfma_f32_32x32x16_bf16 v[80:95], v[132:135], v[28:31], v[80:95]
    ds_read_b64_tr_b16 v[174:175], v5 offset:7424
    s_setprio 0
    ds_read_b32 v245, v244
    ds_read_b64_tr_b16 v[204:205], v9 offset:48
    v_exp_f32 v122, v122
    v_exp_f32 v123, v123
    v_mfma_f32_4x4x4_16b_bf16 v[208:211], v[188:189], v[188:189], v[208:211]
    v_exp_f32 v124, v124
    v_exp_f32 v125, v125
    v_exp_f32 v126, v126
    v_smfmac_f32_32x32x32_bf16 v[48:63], v[152:155], v[112:119], v6
    v_exp_f32 v127, v127
    v_exp_f32 v64, v64
    s_waitcnt lgkmcnt(1)
    v_exp_f32 v65, v65
    v_smfmac_f32_32x32x32_bf16 v[48:63], v[156:159], v[120:127], v6
    s_setprio 3
    v_cmp_ge_u32 vcc, 4, v245
    s_cbranch_vccnz L_spinp4
L_backp4:
    ds_read_b128 v[128:131], v4 offset:16384
    v_exp_f32 v66, v66
    v_exp_f32 v67, v67
    v_cndmask_b32 v14, v208, v209, s[64:65]
    v_exp_f32 v68, v68
    ds_read_b128 v[132:135], v4 offset:17408
    v_cndmask_b32 v14, v14, v210, s[66:67]
    v_cndmask_b32 v14, v14, v211, s[68:69]
    v_exp_f32 v69, v69
    v_sqrt_f32 v14, v14
    v_exp_f32 v70, v70
    v_add_f32 v14, s44, v14
    v_mfma_f32_32x32x16_bf16 v[96:111], v[136:139], v[16:19], 0
    v_exp_f32 v71, v71
    v_exp_f32 v72, v72
    v_rcp_f32 v15, v14
    v_exp_f32 v73, v73
    v_mfma_f32_32x32x16_bf16 v[96:111], v[140:143], v[24:27], v[96:111]
    ds_read_b64_tr_b16 v[144:145], v5 offset:16384
    v_exp_f32 v74, v74
    v_cvt_pk_bf16_f32 v15, v15, v15
    v_and_b32 v206, v15, v10
    v_and_b32 v207, v15, v11
    v_exp_f32 v75, v75
    v_exp_f32 v76, v76
    v_mfma_f32_4x4x4_16b_bf16 v[208:211], v[192:193], v[206:207], 0
    v_exp_f32 v77, v77
    v_smfmac_f32_32x32x32_bf16 v[32:47], v[160:163], v[64:71], v6
    ds_read_b64_tr_b16 v[146:147], v5 offset:16640
    v_exp_f32 v78, v78
    v_exp_f32 v79, v79
    v_exp_f32 v80, v80
    v_mfma_f32_4x4x4_16b_bf16 v[212:215], v[194:195], v[206:207], 0
    v_exp_f32 v81, v81
    v_mfma_f32_4x4x4_16b_bf16 v[216:219], v[196:197], v[206:207], 0
    v_smfmac_f32_32x32x32_bf16 v[32:47], v[164:167], v[72:79], v6
    ds_read_b64_tr_b16 v[148:149], v5 offset:17408
    v_exp_f32 v82, v82
    v_exp_f32 v83, v83
    v_cvt_pk_bf16_f32 v176, v208, v209
    v_exp_f32 v84, v84
    v_cvt_pk_bf16_f32 v177, v210, v211
    v_exp_f32 v85, v85
    v_mfma_f32_32x32x16_bf16 v[112:127], v[136:139], v[20:23], 0
    ds_read_b64_tr_b16 v[150:151], v5 offset:17664
    v_exp_f32 v86, v86
    v_exp_f32 v87, v87
    v_exp_f32 v88, v88
    v_cvt_pk_bf16_f32 v178, v212, v213
    v_cvt_pk_bf16_f32 v179, v214, v215
    v_cvt_pk_bf16_f32 v180, v216, v217
    v_mfma_f32_4x4x4_16b_bf16 v[220:223], v[198:199], v[206:207], 0
    v_mfma_f32_32x32x16_bf16 v[112:127], v[140:143], v[28:31], v[112:127]
    v_exp_f32 v89, v89
    v_exp_f32 v90, v90
    v_exp_f32 v91, v91
    v_exp_f32 v92, v92
    v_mfma_f32_4x4x4_16b_bf16 v[224:227], v[200:201], v[206:207], 0
    v_exp_f32 v93, v93
    v_smfmac_f32_32x32x32_bf16 v[48:63], v[160:163], v[80:87], v6
    v_exp_f32 v94, v94
    v_exp_f32 v95, v95
    v_cvt_pk_bf16_f32 v181, v218, v219
    v_cvt_pk_bf16_f32 v182, v220, v221
    v_exp_f32 v96, v96
    v_mfma_f32_4x4x4_16b_bf16 v[228:231], v[202:203], v[206:207], 0
    v_exp_f32 v97, v97
    v_smfmac_f32_32x32x32_bf16 v[48:63], v[164:167], v[88:95], v6
    s_setprio 2
    ds_read_b128 v[136:139], v4 offset:18432
    s_waitcnt lgkmcnt(5)
    v_exp_f32 v98, v98
    v_cvt_pk_bf16_f32 v183, v222, v223
    v_mfma_f32_4x4x4_16b_bf16 v[232:235], v[204:205], v[206:207], 0
    v_cvt_pk_bf16_f32 v184, v224, v225
    v_exp_f32 v99, v99
    v_exp_f32 v100, v100
    v_mfma_f32_32x32x16_bf16 v[64:79], v[128:131], v[16:19], 0
    v_exp_f32 v101, v101
    ds_read_b128 v[140:143], v4 offset:19456
    ds_write_b128 v3, v[176:179] offset:32768
    v_exp_f32 v102, v102
    v_cvt_pk_bf16_f32 v185, v226, v227
    v_cvt_pk_bf16_f32 v186, v228, v229
    v_exp_f32 v103, v103
    v_exp_f32 v104, v104
    v_exp_f32 v105, v105
    v_mfma_f32_32x32x16_bf16 v[64:79], v[132:135], v[24:27], v[64:79]
    ds_read_b64_tr_b16 v[152:153], v5 offset:18432
    ds_write_b128 v3, v[180:183] offset:33280
    v_cvt_pk_bf16_f32 v187, v230, v231
    v_exp_f32 v106, v106
    v_cvt_pk_bf16_f32 v188, v232, v233
    v_exp_f32 v107, v107
    v_exp_f32 v108, v108
    v_exp_f32 v109, v109
    v_smfmac_f32_32x32x32_bf16 v[32:47], v[168:171], v[96:103], v6
    ds_read_b64_tr_b16 v[154:155], v5 offset:18688
    s_add_u32 s39, s39, 14336
    v_exp_f32 v110, v110
    v_cvt_pk_bf16_f32 v189, v234, v235
    v_exp_f32 v111, v111
    v_exp_f32 v112, v112
    v_exp_f32 v113, v113
    v_smfmac_f32_32x32x32_bf16 v[32:47], v[172:175], v[104:111], v6
    s_setprio 1
    ds_read_b64_tr_b16 v[156:157], v5 offset:19456
    ds_write_b128 v3, v[184:187] offset:33792
    v_exp_f32 v114, v114
    v_exp_f32 v115, v115
    v_exp_f32 v116, v116
    v_exp_f32 v117, v117
    v_mfma_f32_32x32x16_bf16 v[80:95], v[128:131], v[20:23], 0
    ds_write_b128 v3, v[188:191] offset:34304
    v_exp_f32 v118, v118
    v_exp_f32 v119, v119
    v_exp_f32 v120, v120
    v_exp_f32 v121, v121
    v_mfma_f32_32x32x16_bf16 v[80:95], v[132:135], v[28:31], v[80:95]
    ds_read_b64_tr_b16 v[158:159], v5 offset:19712
    v_exp_f32 v122, v122
    v_exp_f32 v123, v123
    v_smfmac_f32_32x32x32_bf16 v[48:63], v[168:171], v[112:119], v6
    s_setprio 0
    v_exp_f32 v124, v124
    v_exp_f32 v125, v125
    s_waitcnt vmcnt(0)
    ds_add_u32 v243, v246
    v_exp_f32 v126, v126
    v_exp_f32 v127, v127
    v_exp_f32 v64, v64
    v_exp_f32 v65, v65
    v_smfmac_f32_32x32x32_bf16 v[48:63], v[172:175], v[120:127], v6
    ds_read_b128 v[128:131], v4 offset:20480
    s_setprio 3
    s_waitcnt lgkmcnt(10)
    v_exp_f32 v66, v66
    v_exp_f32 v67, v67
    v_mfma_f32_32x32x16_bf16 v[96:111], v[136:139], v[16:19], 0
    v_exp_f32 v68, v68
    v_exp_f32 v69, v69
    ds_read_b128 v[132:135], v4 offset:21504
    v_exp_f32 v70, v70
    v_exp_f32 v71, v71
    v_exp_f32 v72, v72
    v_exp_f32 v73, v73
    v_mfma_f32_32x32x16_bf16 v[96:111], v[140:143], v[24:27], v[96:111]
    ds_read_b64_tr_b16 v[160:161], v5 offset:20480
    s_add_u32 m0, s40, 0x8000
    s_mov_b64 exec, s[52:53]
    buffer_load_dwordx4 v2, s[24:27], s39 offen lds
    s_mov_b64 exec, -1
    v_exp_f32 v74, v74
    v_exp_f32 v75, v75
    v_exp_f32 v76, v76
    v_exp_f32 v77, v77
    v_smfmac_f32_32x32x32_bf16 v[32:47], v[144:147], v[64:71], v6
    s_setprio 0
    s_add_u32 m0, s40, 0x8080
    s_mov_b64 exec, s[52:53]
    buffer_load_dwordx4 v2, s[24:27], s39 offen offset:896 lds
    s_mov_b64 exec, -1
    ds_read_b64_tr_b16 v[162:163], v5 offset:20736
    v_exp_f32 v78, v78
    v_exp_f32 v79, v79
    v_exp_f32 v80, v80
    v_exp_f32 v81, v81
    v_smfmac_f32_32x32x32_bf16 v[32:47], v[148:151], v[72:79], v6
    v_exp_f32 v82, v82
    v_exp_f32 v83, v83
    v_exp_f32 v84, v84
    v_exp_f32 v85, v85
    v_mfma_f32_32x32x16_bf16 v[112:127], v[136:139], v[20:23], 0
    ds_read_b64_tr_b16 v[164:165], v5 offset:21504
    ds_read_b64_tr_b16 v[166:167], v5 offset:21760
    v_exp_f32 v86, v86
    v_exp_f32 v87, v87
    v_exp_f32 v88, v88
    v_exp_f32 v89, v89
    v_exp_f32 v90, v90
    v_mfma_f32_32x32x16_bf16 v[112:127], v[140:143], v[28:31], v[112:127]
    v_exp_f32 v91, v91
    v_exp_f32 v92, v92
    v_exp_f32 v93, v93
    v_smfmac_f32_32x32x32_bf16 v[48:63], v[144:147], v[80:87], v6
    v_exp_f32 v94, v94
    v_exp_f32 v95, v95
    v_exp_f32 v96, v96
    v_exp_f32 v97, v97
    v_smfmac_f32_32x32x32_bf16 v[48:63], v[148:151], v[88:95], v6
    s_setprio 2
    s_waitcnt lgkmcnt(4)
    ds_read_b128 v[136:139], v4 offset:22528
    v_exp_f32 v98, v98
    v_exp_f32 v99, v99
    v_exp_f32 v100, v100
    v_exp_f32 v101, v101
    v_mfma_f32_32x32x16_bf16 v[64:79], v[128:131], v[16:19], 0
    ds_read_b128 v[140:143], v4 offset:23552
    v_exp_f32 v102, v102
    v_exp_f32 v103, v103
    v_exp_f32 v104, v104
    v_exp_f32 v105, v105
    v_mfma_f32_32x32x16_bf16 v[64:79], v[132:135], v[24:27], v[64:79]
    s_setprio 2
    ds_read_b64_tr_b16 v[168:169], v5 offset:22528
    v_exp_f32 v106, v106
    v_exp_f32 v107, v107
    v_exp_f32 v108, v108
    v_exp_f32 v109, v109
    v_smfmac_f32_32x32x32_bf16 v[32:47], v[152:155], v[96:103], v6
    ds_read_b64_tr_b16 v[170:171], v5 offset:22784
    v_exp_f32 v110, v110
    v_exp_f32 v111, v111
    v_exp_f32 v112, v112
    v_exp_f32 v113, v113
    v_smfmac_f32_32x32x32_bf16 v[32:47], v[156:159], v[104:111], v6
    ds_read_b64_tr_b16 v[172:173], v5 offset:23552
    v_exp_f32 v114, v114
    s_setprio 1
    v_exp_f32 v115, v115
    v_exp_f32 v116, v116
    v_exp_f32 v117, v117
    v_mfma_f32_32x32x16_bf16 v[80:95], v[128:131], v[20:23], 0
    ds_read_b64_tr_b16 v[174:175], v5 offset:23808
    v_exp_f32 v118, v118
    v_exp_f32 v119, v119
    v_exp_f32 v120, v120
    v_exp_f32 v121, v121
    s_setprio 0
    v_mfma_f32_32x32x16_bf16 v[80:95], v[132:135], v[28:31], v[80:95]
    ds_read_b32 v245, v244
    v_exp_f32 v122, v122
    v_exp_f32 v123, v123
    v_exp_f32 v124, v124
    v_exp_f32 v125, v125
    v_exp_f32 v126, v126
    v_exp_f32 v127, v127
    v_smfmac_f32_32x32x32_bf16 v[48:63], v[152:155], v[112:119], v6
    s_setprio 3
    v_exp_f32 v64, v64
    v_exp_f32 v65, v65
    v_smfmac_f32_32x32x32_bf16 v[48:63], v[156:159], v[120:127], v6
    s_waitcnt lgkmcnt(0)
    v_cmp_ge_u32 vcc, 5, v245
    s_cbranch_vccnz L_spinp5
L_backp5:
    ds_read_b128 v[128:131], v4 offset:32768
    v_exp_f32 v66, v66
    v_exp_f32 v67, v67
    v_exp_f32 v68, v68
    v_exp_f32 v69, v69
    v_mfma_f32_32x32x16_bf16 v[96:111], v[136:139], v[16:19], 0
    ds_read_b128 v[132:135], v4 offset:33792
    v_exp_f32 v70, v70
    v_exp_f32 v71, v71
    v_exp_f32 v72, v72
    v_exp_f32 v73, v73
    v_mfma_f32_32x32x16_bf16 v[96:111], v[140:143], v[24:27], v[96:111]
    ds_read_b64_tr_b16 v[144:145], v5 offset:32768
    ds_read_b64_tr_b16 v[146:147], v5 offset:33024
    v_exp_f32 v74, v74
    v_exp_f32 v75, v75
    v_exp_f32 v76, v76
    v_exp_f32 v77, v77
    v_smfmac_f32_32x32x32_bf16 v[32:47], v[160:163], v[64:71], v6
    v_exp_f32 v78, v78
    v_exp_f32 v79, v79
    v_exp_f32 v80, v80
    v_exp_f32 v81, v81
    v_smfmac_f32_32x32x32_bf16 v[32:47], v[164:167], v[72:79], v6
    ds_read_b64_tr_b16 v[148:149], v5 offset:33792
    v_exp_f32 v82, v82
    v_exp_f32 v83, v83
    v_exp_f32 v84, v84
    ds_read_b64_tr_b16 v[150:151], v5 offset:34048
    v_exp_f32 v85, v85
    v_mfma_f32_32x32x16_bf16 v[112:127], v[136:139], v[20:23], 0
    v_exp_f32 v86, v86
    v_exp_f32 v87, v87
    v_exp_f32 v88, v88
    v_mfma_f32_32x32x16_bf16 v[112:127], v[140:143], v[28:31], v[112:127]
    v_exp_f32 v89, v89
    v_exp_f32 v90, v90
    v_exp_f32 v91, v91
    v_exp_f32 v92, v92
    v_exp_f32 v93, v93
    v_smfmac_f32_32x32x32_bf16 v[48:63], v[160:163], v[80:87], v6
    v_exp_f32 v94, v94
    v_exp_f32 v95, v95
    v_exp_f32 v96, v96
    v_exp_f32 v97, v97
    v_smfmac_f32_32x32x32_bf16 v[48:63], v[164:167], v[88:95], v6
    s_waitcnt lgkmcnt(4)
    ds_read_b128 v[136:139], v4 offset:34816
    s_setprio 2
    v_exp_f32 v98, v98
    v_exp_f32 v99, v99
    v_exp_f32 v100, v100
    v_exp_f32 v101, v101
    v_mfma_f32_32x32x16_bf16 v[64:79], v[128:131], v[16:19], 0
    v_exp_f32 v102, v102
    v_exp_f32 v103, v103
    v_exp_f32 v104, v104
    v_exp_f32 v105, v105
    ds_read_b128 v[140:143], v4 offset:35840
    v_mfma_f32_32x32x16_bf16 v[64:79], v[132:135], v[24:27], v[64:79]
    ds_read_b64_tr_b16 v[152:153], v5 offset:34816
    v_exp_f32 v106, v106
    v_exp_f32 v107, v107
    v_exp_f32 v108, v108
    v_exp_f32 v109, v109
    s_add_u32 s39, s39, 14336
    v_smfmac_f32_32x32x32_bf16 v[32:47], v[168:171], v[96:103], v6
    ds_read_b64_tr_b16 v[154:155], v5 offset:35072
    v_exp_f32 v110, v110
    v_exp_f32 v111, v111
    v_exp_f32 v112, v112
    ds_read_b64_tr_b16 v[156:157], v5 offset:35840
    v_exp_f32 v113, v113
    s_setprio 1
    v_exp_f32 v114, v114
    v_exp_f32 v115, v115
    v_exp_f32 v116, v116
    v_smfmac_f32_32x32x32_bf16 v[32:47], v[172:175], v[104:111], v6
    v_exp_f32 v117, v117
    v_mfma_f32_32x32x16_bf16 v[80:95], v[128:131], v[20:23], 0
    v_exp_f32 v118, v118
    v_exp_f32 v119, v119
    v_exp_f32 v120, v120
    v_exp_f32 v121, v121
    s_setprio 0
    v_mfma_f32_32x32x16_bf16 v[80:95], v[132:135], v[28:31], v[80:95]
    s_waitcnt vmcnt(0)
    ds_read_b64_tr_b16 v[158:159], v5 offset:36096
    v_exp_f32 v122, v122
    v_exp_f32 v123, v123
    v_exp_f32 v124, v124
    v_exp_f32 v125, v125
    v_smfmac_f32_32x32x32_bf16 v[48:63], v[168:171], v[112:119], v6
    ds_add_u32 v243, v246
    v_exp_f32 v126, v126
    v_exp_f32 v127, v127
    v_exp_f32 v64, v64
    v_exp_f32 v65, v65
    s_waitcnt lgkmcnt(5)
    ds_read_b128 v[128:131], v4 offset:36864
    v_exp_f32 v66, v66
    v_exp_f32 v67, v67
    v_exp_f32 v68, v68
    v_smfmac_f32_32x32x32_bf16 v[48:63], v[172:175], v[120:127], v6
    v_exp_f32 v69, v69
    ds_read_b128 v[132:135], v4 offset:37888
    v_exp_f32 v70, v70
    v_mfma_f32_32x32x16_bf16 v[96:111], v[136:139], v[16:19], 0
    v_exp_f32 v71, v71
    v_exp_f32 v72, v72
    v_exp_f32 v73, v73
    v_mfma_f32_32x32x16_bf16 v[96:111], v[140:143], v[24:27], v[96:111]
    ds_read_b64_tr_b16 v[160:161], v5 offset:36864
    v_exp_f32 v74, v74
    v_exp_f32 v75, v75
    v_exp_f32 v76, v76
    v_exp_f32 v77, v77
    v_smfmac_f32_32x32x32_bf16 v[32:47], v[144:147], v[64:71], v6
    ds_read_b64_tr_b16 v[162:163], v5 offset:37120
    v_exp_f32 v78, v78
    v_exp_f32 v79, v79
    v_exp_f32 v80, v80
    v_exp_f32 v81, v81
    v_smfmac_f32_32x32x32_bf16 v[32:47], v[148:151], v[72:79], v6
    ds_read_b64_tr_b16 v[164:165], v5 offset:37888
    v_exp_f32 v82, v82
    v_exp_f32 v83, v83
    v_exp_f32 v84, v84
    v_exp_f32 v85, v85
    v_mfma_f32_32x32x16_bf16 v[112:127], v[136:139], v[20:23], 0
    v_exp_f32 v86, v86
    ds_read_b64_tr_b16 v[166:167], v5 offset:38144
    v_exp_f32 v87, v87
    v_exp_f32 v88, v88
    v_exp_f32 v89, v89
    v_mfma_f32_32x32x16_bf16 v[112:127], v[140:143], v[28:31], v[112:127]
    v_exp_f32 v90, v90
    v_exp_f32 v91, v91
    v_exp_f32 v92, v92
    v_exp_f32 v93, v93
    v_smfmac_f32_32x32x32_bf16 v[48:63], v[144:147], v[80:87], v6
    v_exp_f32 v94, v94
    v_exp_f32 v95, v95
    v_exp_f32 v96, v96
    v_exp_f32 v97, v97
    v_smfmac_f32_32x32x32_bf16 v[48:63], v[148:151], v[88:95], v6
    s_waitcnt lgkmcnt(4)
    ds_read_b128 v[136:139], v4 offset:38912
    s_setprio 2
    v_exp_f32 v98, v98
    v_exp_f32 v99, v99
    v_exp_f32 v100, v100
    v_exp_f32 v101, v101
    ds_read_b128 v[140:143], v4 offset:39936
    v_mfma_f32_32x32x16_bf16 v[64:79], v[128:131], v[16:19], 0
    v_exp_f32 v102, v102
    v_exp_f32 v103, v103
    v_exp_f32 v104, v104
    v_exp_f32 v105, v105
    v_mfma_f32_32x32x16_bf16 v[64:79], v[132:135], v[24:27], v[64:79]
    ds_read_b64_tr_b16 v[168:169], v5 offset:38912
    v_exp_f32 v106, v106
    v_exp_f32 v107, v107
    v_exp_f32 v108, v108
    s_setprio 1
    ds_read_b64_tr_b16 v[170:171], v5 offset:39168
    v_smfmac_f32_32x32x32_bf16 v[32:47], v[152:155], v[96:103], v6
    v_exp_f32 v109, v109
    v_exp_f32 v110, v110
    v_exp_f32 v111, v111
    v_exp_f32 v112, v112
    v_exp_f32 v113, v113
    v_smfmac_f32_32x32x32_bf16 v[32:47], v[156:159], v[104:111], v6
    ds_read_b64_tr_b16 v[172:173], v5 offset:39936
    v_exp_f32 v114, v114
    v_exp_f32 v115, v115
    v_exp_f32 v116, v116
    v_exp_f32 v117, v117
    v_mfma_f32_32x32x16_bf16 v[80:95], v[128:131], v[20:23], 0
    ds_read_b64_tr_b16 v[174:175], v5 offset:40192
    v_exp_f32 v118, v118
    v_exp_f32 v119, v119
    v_exp_f32 v120, v120
    v_exp_f32 v121, v121
    ds_read_b32 v245, v244
    s_setprio 0
    v_mfma_f32_32x32x16_bf16 v[80:95], v[132:135], v[28:31], v[80:95]
    v_exp_f32 v122, v122
    v_exp_f32 v123, v123
    v_smfmac_f32_32x32x32_bf16 v[48:63], v[152:155], v[112:119], v6
    v_exp_f32 v124, v124
    v_exp_f32 v125, v125
    v_exp_f32 v126, v126
    v_exp_f32 v127, v127
    v_exp_f32 v64, v64
    v_exp_f32 v65, v65
    v_smfmac_f32_32x32x32_bf16 v[48:63], v[156:159], v[120:127], v6
    s_waitcnt lgkmcnt(0)
    v_cmp_ge_u32 vcc, 6, v245
    s_cbranch_vccnz L_spinp6
L_backp6:
    v_exp_f32 v66, v66
    ds_read_b128 v[128:131], v4 offset:49152
    v_exp_f32 v67, v67
    v_exp_f32 v68, v68
    v_exp_f32 v69, v69
    v_mfma_f32_32x32x16_bf16 v[96:111], v[136:139], v[16:19], 0
    s_setprio 1
    ds_read_b128 v[132:135], v4 offset:50176
    v_exp_f32 v70, v70
    v_exp_f32 v71, v71
    v_exp_f32 v72, v72
    v_exp_f32 v73, v73
    v_mfma_f32_32x32x16_bf16 v[96:111], v[140:143], v[24:27], v[96:111]
    s_setprio 2
    ds_read_b64_tr_b16 v[144:145], v5 offset:49152
    v_exp_f32 v74, v74
    v_exp_f32 v75, v75
    v_exp_f32 v76, v76
    v_exp_f32 v77, v77
    v_smfmac_f32_32x32x32_bf16 v[32:47], v[160:163], v[64:71], v6
    ds_read_b64_tr_b16 v[146:147], v5 offset:49408
    v_exp_f32 v78, v78
    v_exp_f32 v79, v79
    v_exp_f32 v80, v80
    v_exp_f32 v81, v81
    v_smfmac_f32_32x32x32_bf16 v[32:47], v[164:167], v[72:79], v6
    ds_read_b64_tr_b16 v[148:149], v5 offset:50176
    ds_read_b64_tr_b16 v[150:151], v5 offset:50432
    v_exp_f32 v82, v82
    v_exp_f32 v83, v83
    v_exp_f32 v84, v84
    v_exp_f32 v85, v85
    v_mfma_f32_32x32x16_bf16 v[112:127], v[136:139], v[20:23], 0
    v_exp_f32 v86, v86
    v_exp_f32 v87, v87
    v_mfma_f32_32x32x16_bf16 v[112:127], v[140:143], v[28:31], v[112:127]
    v_exp_f32 v88, v88
    v_exp_f32 v89, v89
    v_exp_f32 v90, v90
    v_exp_f32 v91, v91
    v_exp_f32 v92, v92
    v_smfmac_f32_32x32x32_bf16 v[48:63], v[160:163], v[80:87], v6
    v_exp_f32 v93, v93
    v_exp_f32 v94, v94
    v_exp_f32 v95, v95
    v_exp_f32 v96, v96
    v_exp_f32 v97, v97
    s_waitcnt lgkmcnt(4)
    ds_read_b128 v[136:139], v4 offset:51200
    v_smfmac_f32_32x32x32_bf16 v[48:63], v[164:167], v[88:95], v6
    v_exp_f32 v98, v98
    v_exp_f32 v99, v99
    v_mfma_f32_32x32x16_bf16 v[64:79], v[128:131], v[16:19], 0
    s_setprio 2
    v_exp_f32 v100, v100
    v_exp_f32 v101, v101
    v_exp_f32 v102, v102
    v_exp_f32 v103, v103
    v_exp_f32 v104, v104
    ds_read_b128 v[140:143], v4 offset:52224
    v_exp_f32 v105, v105
    s_setprio 1
    v_mfma_f32_32x32x16_bf16 v[64:79], v[132:135], v[24:27], v[64:79]
    ds_read_b64_tr_b16 v[152:153], v5 offset:51200
    v_exp_f32 v106, v106
    v_exp_f32 v107, v107
    v_exp_f32 v108, v108
    v_exp_f32 v109, v109
    v_smfmac_f32_32x32x32_bf16 v[32:47], v[168:171], v[96:103], v6
    ds_read_b64_tr_b16 v[154:155], v5 offset:51456
    v_exp_f32 v110, v110
    v_exp_f32 v111, v111
    ds_read_b64_tr_b16 v[156:157], v5 offset:52224
    v_exp_f32 v112, v112
    v_exp_f32 v113, v113
    v_smfmac_f32_32x32x32_bf16 v[32:47], v[172:175], v[104:111], v6
    s_setprio 1
    v_exp_f32 v114, v114
    s_setprio 0
    v_exp_f32 v115, v115
    v_exp_f32 v116, v116
    v_exp_f32 v117, v117
    v_mfma_f32_32x32x16_bf16 v[80:95], v[128:131], v[20:23], 0
    ds_read_b64_tr_b16 v[158:159], v5 offset:52480
    v_exp_f32 v118, v118
    v_exp_f32 v119, v119
    v_exp_f32 v120, v120
    v_mfma_f32_32x32x16_bf16 v[80:95], v[132:135], v[28:31], v[80:95]
    v_exp_f32 v121, v121
    v_exp_f32 v122, v122
    v_exp_f32 v123, v123
    v_exp_f32 v124, v124
    v_exp_f32 v125, v125
    v_smfmac_f32_32x32x32_bf16 v[48:63], v[168:171], v[112:119], v6
    v_exp_f32 v126, v126
    v_exp_f32 v127, v127
    v_exp_f32 v64, v64
    v_exp_f32 v65, v65
    v_smfmac_f32_32x32x32_bf16 v[48:63], v[172:175], v[120:127], v6
    s_waitcnt lgkmcnt(4)
    v_exp_f32 v66, v66
    v_exp_f32 v67, v67
    s_setprio 3
    ds_read_b128 v[128:131], v4 offset:53248
    v_exp_f32 v68, v68
    v_exp_f32 v69, v69
    ds_read_b128 v[132:135], v4 offset:54272
    v_mfma_f32_32x32x16_bf16 v[96:111], v[136:139], v[16:19], 0
    s_setprio 2
    v_exp_f32 v70, v70
    v_exp_f32 v71, v71
    v_exp_f32 v72, v72
    ds_read_b64_tr_b16 v[160:161], v5 offset:53248
    v_exp_f32 v73, v73
    v_mfma_f32_32x32x16_bf16 v[96:111], v[140:143], v[24:27], v[96:111]
    v_exp_f32 v74, v74
    v_exp_f32 v75, v75
    v_exp_f32 v76, v76
    v_smfmac_f32_32x32x32_bf16 v[32:47], v[144:147], v[64:71], v6
    v_exp_f32 v77, v77
    ds_read_b64_tr_b16 v[162:163], v5 offset:53504
    v_exp_f32 v78, v78
    v_exp_f32 v79, v79
    v_exp_f32 v80, v80
    v_exp_f32 v81, v81
    ds_read_b64_tr_b16 v[164:165], v5 offset:54272
    ds_read_b64_tr_b16 v[166:167], v5 offset:54528
    v_exp_f32 v82, v82
    v_smfmac_f32_32x32x32_bf16 v[32:47], v[148:151], v[72:79], v6
    v_exp_f32 v83, v83
    v_mfma_f32_32x32x16_bf16 v[112:127], v[136:139], v[20:23], 0
    v_exp_f32 v84, v84
    v_exp_f32 v85, v85
    v_exp_f32 v86, v86
    v_mfma_f32_32x32x16_bf16 v[112:127], v[140:143], v[28:31], v[112:127]
    v_exp_f32 v87, v87
    v_exp_f32 v88, v88
    v_exp_f32 v89, v89
    v_exp_f32 v90, v90
    v_exp_f32 v91, v91
    v_exp_f32 v92, v92
    v_exp_f32 v93, v93
    v_smfmac_f32_32x32x32_bf16 v[48:63], v[144:147], v[80:87], v6
    v_exp_f32 v94, v94
    v_exp_f32 v95, v95
    s_waitcnt lgkmcnt(4)
    v_exp_f32 v96, v96
    v_exp_f32 v97, v97
    v_smfmac_f32_32x32x32_bf16 v[48:63], v[148:151], v[88:95], v6
    s_setprio 3
    ds_read_b128 v[136:139], v4 offset:55296
    v_exp_f32 v98, v98
    v_exp_f32 v99, v99
    ds_read_b128 v[140:143], v4 offset:56320
    v_exp_f32 v100, v100
    v_exp_f32 v101, v101
    v_mfma_f32_32x32x16_bf16 v[64:79], v[128:131], v[16:19], 0
    v_exp_f32 v102, v102
    v_exp_f32 v103, v103
    v_exp_f32 v104, v104
    v_exp_f32 v105, v105
    ds_read_b64_tr_b16 v[168:169], v5 offset:55296
    v_mfma_f32_32x32x16_bf16 v[64:79], v[132:135], v[24:27], v[64:79]
    v_exp_f32 v106, v106
    v_exp_f32 v107, v107
    v_exp_f32 v108, v108
    v_exp_f32 v109, v109
    v_smfmac_f32_32x32x32_bf16 v[32:47], v[152:155], v[96:103], v6
    ds_read_b64_tr_b16 v[170:171], v5 offset:55552
    v_exp_f32 v110, v110
    v_exp_f32 v111, v111
    v_exp_f32 v112, v112
    v_exp_f32 v113, v113
    v_smfmac_f32_32x32x32_bf16 v[32:47], v[156:159], v[104:111], v6
    s_setprio 1
    s_waitcnt lgkmcnt(2)
    ds_read_b64_tr_b16 v[172:173], v5 offset:56320
    v_exp_f32 v114, v114
    v_exp_f32 v115, v115
    v_exp_f32 v116, v116
    v_exp_f32 v117, v117
    ds_read_b64_tr_b16 v[174:175], v5 offset:56576
    v_mfma_f32_32x32x16_bf16 v[96:111], v[136:139], v[16:19], 0
    v_exp_f32 v118, v118
    v_exp_f32 v119, v119
    v_exp_f32 v120, v120
    v_exp_f32 v121, v121
    v_mfma_f32_32x32x16_bf16 v[96:111], v[140:143], v[24:27], v[96:111]
    v_exp_f32 v122, v122
    v_smfmac_f32_32x32x32_bf16 v[48:63], v[152:155], v[112:119], v6
    v_exp_f32 v123, v123
    v_exp_f32 v124, v124
    v_exp_f32 v125, v125
    s_setprio 0
    v_exp_f32 v126, v126
    v_exp_f32 v127, v127
    v_exp_f32 v64, v64
    v_exp_f32 v65, v65
    v_smfmac_f32_32x32x32_bf16 v[48:63], v[156:159], v[120:127], v6
    s_setprio 3
    v_exp_f32 v66, v66
    v_exp_f32 v67, v67
    s_setprio 3
    v_exp_f32 v68, v68
    v_exp_f32 v69, v69
    v_mfma_f32_32x32x16_bf16 v[80:95], v[128:131], v[20:23], 0
    v_exp_f32 v70, v70
    v_exp_f32 v71, v71
    v_exp_f32 v72, v72
    v_exp_f32 v73, v73
    v_mfma_f32_32x32x16_bf16 v[80:95], v[132:135], v[28:31], v[80:95]
    v_exp_f32 v74, v74
    v_exp_f32 v75, v75
    v_exp_f32 v76, v76
    v_exp_f32 v77, v77
    v_smfmac_f32_32x32x32_bf16 v[32:47], v[160:163], v[64:71], v6
    v_exp_f32 v78, v78
    v_exp_f32 v79, v79
    v_exp_f32 v96, v96
    v_exp_f32 v97, v97
    v_smfmac_f32_32x32x32_bf16 v[32:47], v[164:167], v[72:79], v6
    s_waitcnt lgkmcnt(0)
    v_exp_f32 v98, v98
    v_exp_f32 v99, v99
    v_exp_f32 v100, v100
    v_exp_f32 v101, v101
    v_exp_f32 v102, v102
    v_mfma_f32_32x32x16_bf16 v[112:127], v[136:139], v[20:23], 0
    v_exp_f32 v103, v103
    v_exp_f32 v104, v104
    v_exp_f32 v105, v105
    v_exp_f32 v106, v106
    v_mfma_f32_32x32x16_bf16 v[112:127], v[140:143], v[28:31], v[112:127]
    v_exp_f32 v107, v107
    v_exp_f32 v108, v108
    v_exp_f32 v109, v109
    v_exp_f32 v110, v110
    v_smfmac_f32_32x32x32_bf16 v[32:47], v[168:171], v[96:103], v6
    v_exp_f32 v111, v111
    v_exp_f32 v80, v80
    v_exp_f32 v81, v81
    v_smfmac_f32_32x32x32_bf16 v[32:47], v[172:175], v[104:111], v6
    v_exp_f32 v82, v82
    v_exp_f32 v83, v83
    v_exp_f32 v84, v84
    v_exp_f32 v85, v85
    s_nop 0
    s_setprio 0
    v_exp_f32 v86, v86
    v_exp_f32 v87, v87
    v_exp_f32 v88, v88
    v_exp_f32 v89, v89
    v_smfmac_f32_32x32x32_bf16 v[48:63], v[160:163], v[80:87], v6
    s_nop 0
    ds_write_b128 v248, v[32:35] offset:0
    ds_write_b128 v248, v[36:39] offset:1024
    ds_write_b128 v248, v[40:43] offset:2048
    v_exp_f32 v90, v90
    ds_write_b128 v248, v[44:47] offset:3072
    v_exp_f32 v91, v91
    v_exp_f32 v92, v92
    v_exp_f32 v93, v93
    v_exp_f32 v94, v94
    v_exp_f32 v95, v95
    v_exp_f32 v112, v112
    v_exp_f32 v113, v113
    v_smfmac_f32_32x32x32_bf16 v[48:63], v[164:167], v[88:95], v6
    s_waitcnt lgkmcnt(0)
    s_barrier
    ds_read_b128 v[208:211], v249 offset:0
    v_exp_f32 v114, v114
    v_exp_f32 v115, v115
    v_exp_f32 v116, v116
    ds_read_b128 v[212:215], v249 offset:1024
    ds_read_b128 v[216:219], v249 offset:2048
    ds_read_b128 v[220:223], v249 offset:3072
    v_exp_f32 v117, v117
    v_exp_f32 v118, v118
    v_exp_f32 v119, v119
    v_exp_f32 v120, v120
    v_exp_f32 v121, v121
    s_waitcnt lgkmcnt(0)
    v_pk_add_f32 v[48:49], v[48:49], v[208:209]
    v_pk_add_f32 v[50:51], v[50:51], v[210:211]
    v_pk_add_f32 v[52:53], v[52:53], v[212:213]
    v_pk_add_f32 v[54:55], v[54:55], v[214:215]
    v_pk_add_f32 v[56:57], v[56:57], v[216:217]
    v_pk_add_f32 v[58:59], v[58:59], v[218:219]
    v_pk_add_f32 v[60:61], v[60:61], v[220:221]
    v_pk_add_f32 v[62:63], v[62:63], v[222:223]
    v_exp_f32 v122, v122
    v_exp_f32 v123, v123
    v_smfmac_f32_32x32x32_bf16 v[48:63], v[168:171], v[112:119], v6
    v_exp_f32 v124, v124
    v_exp_f32 v125, v125
    v_exp_f32 v126, v126
    v_exp_f32 v127, v127
    s_nop 1
    v_smfmac_f32_32x32x32_bf16 v[48:63], v[172:175], v[120:127], v6
    s_branch L_fin
.p2align 5
L_B1:
    v_exp_f32 v80, v80
    v_exp_f32 v81, v81
    v_smfmac_f32_32x32x32_bf16 v[32:47], v[148:151], v[72:79], v6
    s_waitcnt vmcnt(2)
    ds_read_b64_tr_b16 v[164:165], v5 offset:5120
    ds_read2_b64 v[176:179], v251 offset0:0 offset1:1
    ds_read2_b64 v[180:183], v251 offset0:2 offset1:3
    v_exp_f32 v82, v82
    v_exp_f32 v83, v83
    v_exp_f32 v84, v84
    v_exp_f32 v85, v85
    v_mfma_f32_32x32x16_bf16 v[112:127], v[136:139], v[20:23], 0
    ds_read_b64_tr_b16 v[166:167], v5 offset:5376
    ds_read2_b64 v[184:187], v251 offset0:4 offset1:5
    ds_read_b64 v[188:189], v251 offset:48
    v_exp_f32 v86, v86
    ds_read_b64_tr_b16 v[192:193], v252 offset:0
    v_exp_f32 v87, v87
    v_exp_f32 v88, v88
    v_exp_f32 v89, v89
    v_mfma_f32_32x32x16_bf16 v[112:127], v[140:143], v[28:31], v[112:127]
    s_waitcnt lgkmcnt(2)
    ds_read_b64_tr_b16 v[194:195], v252 offset:8
    ds_read_b64_tr_b16 v[196:197], v252 offset:16
    v_exp_f32 v90, v90
    v_mfma_f32_4x4x4_16b_bf16 v[208:211], v[176:177], v[176:177], 0
    v_exp_f32 v91, v91
    v_exp_f32 v92, v92
    v_mfma_f32_4x4x4_16b_bf16 v[208:211], v[178:179], v[178:179], v[208:211]
    v_exp_f32 v93, v93
    v_smfmac_f32_32x32x32_bf16 v[48:63], v[144:147], v[80:87], v6
    ds_read_b64_tr_b16 v[198:199], v252 offset:24
    ds_read_b64_tr_b16 v[200:201], v252 offset:32
    v_mfma_f32_4x4x4_16b_bf16 v[208:211], v[180:181], v[180:181], v[208:211]
    v_exp_f32 v94, v94
    v_exp_f32 v95, v95
    v_mfma_f32_4x4x4_16b_bf16 v[208:211], v[182:183], v[182:183], v[208:211]
    v_exp_f32 v96, v96
    v_exp_f32 v97, v97
    v_mfma_f32_4x4x4_16b_bf16 v[208:211], v[184:185], v[184:185], v[208:211]
    v_smfmac_f32_32x32x32_bf16 v[48:63], v[148:151], v[88:95], v6
    s_waitcnt lgkmcnt(4)
    ds_read_b128 v[136:139], v4 offset:6144
    ds_read_b64_tr_b16 v[202:203], v252 offset:40
    ds_read_b64_tr_b16 v[204:205], v252 offset:48
    v_exp_f32 v98, v98
    v_mfma_f32_4x4x4_16b_bf16 v[208:211], v[186:187], v[186:187], v[208:211]
    v_exp_f32 v99, v99
    v_exp_f32 v100, v100
    v_mfma_f32_4x4x4_16b_bf16 v[208:211], v[188:189], v[188:189], v[208:211]
    v_exp_f32 v101, v101
    v_mfma_f32_32x32x16_bf16 v[64:79], v[128:131], v[16:19], 0
    ds_read_b128 v[140:143], v4 offset:7168
    v_exp_f32 v102, v102
    v_exp_f32 v103, v103
    v_exp_f32 v104, v104
    v_cndmask_b32 v14, v208, v209, s[64:65]
    v_exp_f32 v105, v105
    v_cndmask_b32 v14, v14, v210, s[66:67]
    v_cndmask_b32 v14, v14, v211, s[68:69]
    v_mfma_f32_32x32x16_bf16 v[64:79], v[132:135], v[24:27], v[64:79]
    ds_read_b64_tr_b16 v[168:169], v5 offset:6144
    v_exp_f32 v106, v106
    v_sqrt_f32 v14, v14
    v_exp_f32 v107, v107
    v_add_f32 v14, s44, v14
    v_exp_f32 v108, v108
    v_rcp_f32 v15, v14
    v_exp_f32 v109, v109
    v_smfmac_f32_32x32x32_bf16 v[32:47], v[152:155], v[96:103], v6
    ds_read_b64_tr_b16 v[170:171], v5 offset:6400
    v_cvt_pk_bf16_f32 v15, v15, v15
    v_exp_f32 v110, v110
    v_and_b32 v206, v15, v10
    v_and_b32 v207, v15, v11
    v_exp_f32 v111, v111
    v_exp_f32 v112, v112
    v_exp_f32 v113, v113
    v_mfma_f32_4x4x4_16b_bf16 v[208:211], v[192:193], v[206:207], 0
    v_smfmac_f32_32x32x32_bf16 v[32:47], v[156:159], v[104:111], v6
    s_waitcnt lgkmcnt(2)
    ds_read_b64_tr_b16 v[172:173], v5 offset:7168
    v_exp_f32 v114, v114
    v_mfma_f32_4x4x4_16b_bf16 v[212:215], v[194:195], v[206:207], 0
    v_exp_f32 v115, v115
    v_exp_f32 v116, v116
    v_mfma_f32_4x4x4_16b_bf16 v[216:219], v[196:197], v[206:207], 0
    v_exp_f32 v117, v117
    v_mfma_f32_32x32x16_bf16 v[80:95], v[128:131], v[20:23], 0
    ds_read_b64_tr_b16 v[174:175], v5 offset:7424
    v_cvt_pk_bf16_f32 v176, v208, v209
    v_mfma_f32_4x4x4_16b_bf16 v[220:223], v[198:199], v[206:207], 0
    v_exp_f32 v118, v118
    v_cvt_pk_bf16_f32 v177, v210, v211
    v_exp_f32 v119, v119
    v_cvt_pk_bf16_f32 v178, v212, v213
    v_mfma_f32_4x4x4_16b_bf16 v[224:227], v[200:201], v[206:207], 0
    v_exp_f32 v120, v120
    v_cvt_pk_bf16_f32 v179, v214, v215
    v_exp_f32 v121, v121
    v_mfma_f32_32x32x16_bf16 v[80:95], v[132:135], v[28:31], v[80:95]
    ds_write_b128 v3, v[176:179] offset:0
    v_cvt_pk_bf16_f32 v180, v216, v217
    v_exp_f32 v122, v122
    v_mfma_f32_4x4x4_16b_bf16 v[228:231], v[202:203], v[206:207], 0
    v_cvt_pk_bf16_f32 v181, v218, v219
    v_exp_f32 v123, v123
    v_cvt_pk_bf16_f32 v182, v220, v221
    v_mfma_f32_4x4x4_16b_bf16 v[232:235], v[204:205], v[206:207], 0
    v_exp_f32 v124, v124
    v_cvt_pk_bf16_f32 v183, v222, v223
    v_exp_f32 v125, v125
    v_smfmac_f32_32x32x32_bf16 v[48:63], v[152:155], v[112:119], v6
    ds_write_b128 v3, v[180:183] offset:512
    v_cvt_pk_bf16_f32 v184, v224, v225
    v_exp_f32 v126, v126
    v_cvt_pk_bf16_f32 v185, v226, v227
    v_exp_f32 v127, v127
    v_cvt_pk_bf16_f32 v186, v228, v229
    v_exp_f32 v64, v64
    v_cvt_pk_bf16_f32 v187, v230, v231
    v_exp_f32 v65, v65
    v_smfmac_f32_32x32x32_bf16 v[48:63], v[156:159], v[120:127], v6
    v_cvt_pk_bf16_f32 v188, v232, v233
    v_cvt_pk_bf16_f32 v189, v234, v235
    ds_write_b128 v3, v[184:187] offset:1024
    ds_write_b128 v3, v[188:191] offset:1536
    s_waitcnt vmcnt(0)
    ds_add_u32 v243, v246
    s_setprio 1
    v_exp_f32 v66, v66
    v_exp_f32 v67, v67
    v_exp_f32 v68, v68
    v_exp_f32 v69, v69
    v_mfma_f32_32x32x16_bf16 v[96:111], v[136:139], v[16:19], 0
    s_add_u32 m0, s40, 0x4000
    s_mov_b64 exec, s[52:53]
    buffer_load_dwordx4 v2, s[24:27], s39 offen lds
    s_mov_b64 exec, -1
    v_exp_f32 v70, v70
    v_exp_f32 v71, v71
    v_exp_f32 v72, v72
    v_exp_f32 v73, v73
    v_mfma_f32_32x32x16_bf16 v[96:111], v[140:143], v[24:27], v[96:111]
    s_add_u32 m0, s40, 0x4080
    s_mov_b64 exec, s[52:53]
    buffer_load_dwordx4 v2, s[24:27], s39 offen offset:896 lds
    s_mov_b64 exec, -1
    v_exp_f32 v74, v74
    v_exp_f32 v75, v75
    v_exp_f32 v76, v76
    v_exp_f32 v77, v77
    v_smfmac_f32_32x32x32_bf16 v[32:47], v[160:163], v[64:71], v6
    s_setprio 0
    ds_read_b32 v245, v244
    v_exp_f32 v78, v78
    v_exp_f32 v79, v79
    v_exp_f32 v80, v80
    v_exp_f32 v81, v81
    v_smfmac_f32_32x32x32_bf16 v[32:47], v[164:167], v[72:79], v6
    s_setprio 3
    s_waitcnt lgkmcnt(0)
    v_cmp_ge_u32 vcc, 0, v245
    s_cbranch_vccnz L_spinq0
L_backq0:
    ds_read_b128 v[128:131], v4 offset:16384
    ds_read_b128 v[132:135], v4 offset:17408
    v_exp_f32 v82, v82
    v_exp_f32 v83, v83
    v_exp_f32 v84, v84
    v_exp_f32 v85, v85
    v_mfma_f32_32x32x16_bf16 v[112:127], v[136:139], v[20:23], 0
    ds_read_b64_tr_b16 v[144:145], v5 offset:16384
    ds_read_b64_tr_b16 v[146:147], v5 offset:16640
    v_exp_f32 v86, v86
    v_exp_f32 v87, v87
    v_exp_f32 v88, v88
    v_exp_f32 v89, v89
    v_mfma_f32_32x32x16_bf16 v[112:127], v[140:143], v[28:31], v[112:127]
    ds_read_b64_tr_b16 v[148:149], v5 offset:17408
    ds_read_b64_tr_b16 v[150:151], v5 offset:17664
    s_mov_b32 m0, s41
    s_nop 0
    buffer_load_dwordx4 v1, s[20:23], s38 offen offset:0 lds
    v_exp_f32 v90, v90
    v_exp_f32 v91, v91
    v_exp_f32 v92, v92
    v_exp_f32 v93, v93
    v_smfmac_f32_32x32x32_bf16 v[48:63], v[160:163], v[80:87], v6
    buffer_load_dwordx4 v1, s[20:23], s38 offen offset:1024 lds
    buffer_load_dwordx4 v1, s[20:23], s38 offen offset:2048 lds
    s_mov_b32 exec_hi, 0
    buffer_load_dwordx4 v1, s[20:23], s38 offen offset:3072 lds
    s_mov_b32 exec_hi, -1
    s_add_u32 s38, s38, 28672
    v_exp_f32 v94, v94
    v_exp_f32 v95, v95
    v_exp_f32 v96, v96
    s_waitcnt lgkmcnt(4)
    v_exp_f32 v97, v97
    v_smfmac_f32_32x32x32_bf16 v[48:63], v[164:167], v[88:95], v6
    s_setprio 2
    ds_read_b128 v[136:139], v4 offset:18432
    v_exp_f32 v98, v98
    v_exp_f32 v99, v99
    v_exp_f32 v100, v100
    v_exp_f32 v101, v101
    v_mfma_f32_32x32x16_bf16 v[64:79], v[128:131], v[16:19], 0
    v_exp_f32 v102, v102
    v_exp_f32 v103, v103
    v_exp_f32 v104, v104
    v_exp_f32 v105, v105
    v_mfma_f32_32x32x16_bf16 v[64:79], v[132:135], v[24:27], v[64:79]
    ds_read_b128 v[140:143], v4 offset:19456
    ds_read_b64_tr_b16 v[152:153], v5 offset:18432
    v_exp_f32 v106, v106
    v_exp_f32 v107, v107
    v_exp_f32 v108, v108
    v_exp_f32 v109, v109
    v_smfmac_f32_32x32x32_bf16 v[32:47], v[168:171], v[96:103], v6
    s_setprio 3
    s_add_u32 s39, s39, 14336
    ds_read_b64_tr_b16 v[154:155], v5 offset:18688
    v_exp_f32 v110, v110
    v_exp_f32 v111, v111
    v_exp_f32 v112, v112
    v_exp_f32 v113, v113
    ds_read_b64_tr_b16 v[156:157], v5 offset:19456
    v_exp_f32 v114, v114
    v_exp_f32 v115, v115
    v_smfmac_f32_32x32x32_bf16 v[32:47], v[172:175], v[104:111], v6
    v_exp_f32 v116, v116
    v_exp_f32 v117, v117
    v_mfma_f32_32x32x16_bf16 v[80:95], v[128:131], v[20:23], 0
    s_setprio 0
    v_exp_f32 v118, v118
    v_exp_f32 v119, v119
    ds_read_b64_tr_b16 v[158:159], v5 offset:19712
    v_exp_f32 v120, v120
    v_exp_f32 v121, v121
    v_mfma_f32_32x32x16_bf16 v[80:95], v[132:135], v[28:31], v[80:95]
    v_exp_f32 v122, v122
    v_exp_f32 v123, v123
    v_exp_f32 v124, v124
    v_exp_f32 v125, v125
    v_smfmac_f32_32x32x32_bf16 v[48:63], v[168:171], v[112:119], v6
    s_waitcnt vmcnt(0)
    ds_add_u32 v243, v246
    v_exp_f32 v126, v126
    v_exp_f32 v127, v127
    v_exp_f32 v64, v64
    v_exp_f32 v65, v65
    v_smfmac_f32_32x32x32_bf16 v[48:63], v[172:175], v[120:127], v6
    s_setprio 3
    ds_read_b128 v[128:131], v4 offset:20480
    s_waitcnt lgkmcnt(6)
    v_exp_f32 v66, v66
    v_exp_f32 v67, v67
    v_exp_f32 v68, v68
    v_exp_f32 v69, v69
    v_mfma_f32_32x32x16_bf16 v[96:111], v[136:139], v[16:19], 0
    v_exp_f32 v70, v70
    v_exp_f32 v71, v71
    v_exp_f32 v72, v72
    v_exp_f32 v73, v73
    ds_read_b128 v[132:135], v4 offset:21504
    v_mfma_f32_32x32x16_bf16 v[96:111], v[140:143], v[24:27], v[96:111]
    ds_read_b64_tr_b16 v[160:161], v5 offset:20480
    v_exp_f32 v74, v74
    v_exp_f32 v75, v75
    s_add_u32 m0, s40, 0x8000
    s_mov_b64 exec, s[52:53]
    buffer_load_dwordx4 v2, s[24:27], s39 offen lds
    s_mov_b64 exec, -1
    v_exp_f32 v76, v76
    v_exp_f32 v77, v77
    v_smfmac_f32_32x32x32_bf16 v[32:47], v[144:147], v[64:71], v6
    ds_read_b64_tr_b16 v[162:163], v5 offset:20736
    v_exp_f32 v78, v78
    s_add_u32 m0, s40, 0x8080
    s_mov_b64 exec, s[52:53]
    buffer_load_dwordx4 v2, s[24:27], s39 offen offset:896 lds
    s_mov_b64 exec, -1
    v_exp_f32 v79, v79
    v_exp_f32 v80, v80
    v_exp_f32 v81, v81
    v_smfmac_f32_32x32x32_bf16 v[32:47], v[148:151], v[72:79], v6
    ds_read_b64_tr_b16 v[164:165], v5 offset:21504
    ds_read2_b64 v[176:179], v8 offset0:0 offset1:1
    v_exp_f32 v82, v82
    v_exp_f32 v83, v83
    v_exp_f32 v84, v84
    v_mfma_f32_32x32x16_bf16 v[112:127], v[136:139], v[20:23], 0
    v_exp_f32 v85, v85
    ds_read_b64_tr_b16 v[166:167], v5 offset:21760
    ds_read2_b64 v[180:183], v8 offset0:2 offset1:3
    v_mfma_f32_32x32x16_bf16 v[112:127], v[140:143], v[28:31], v[112:127]
    v_exp_f32 v86, v86
    v_exp_f32 v87, v87
    v_exp_f32 v88, v88
    ds_read2_b64 v[184:187], v8 offset0:4 offset1:5
    v_exp_f32 v89, v89
    v_exp_f32 v90, v90
    v_exp_f32 v91, v91
    v_exp_f32 v92, v92
    v_exp_f32 v93, v93
    v_smfmac_f32_32x32x32_bf16 v[48:63], v[144:147], v[80:87], v6
    s_setprio 2
    ds_read_b64 v[188:189], v8 offset:48
    v_exp_f32 v94, v94
    v_exp_f32 v95, v95
    v_exp_f32 v96, v96
    v_exp_f32 v97, v97
    v_smfmac_f32_32x32x32_bf16 v[48:63], v[148:151], v[88:95], v6
    ds_read_b128 v[136:139], v4 offset:22528
    s_waitcnt lgkmcnt(1)
    ds_read_b64_tr_b16 v[192:193], v9 offset:0
    v_exp_f32 v98, v98
    v_exp_f32 v99, v99
    v_exp_f32 v100, v100
    v_mfma_f32_4x4x4_16b_bf16 v[208:211], v[176:177], v[176:177], 0
    v_exp_f32 v101, v101
    v_mfma_f32_32x32x16_bf16 v[64:79], v[128:131], v[16:19], 0
    ds_read_b128 v[140:143], v4 offset:23552
    ds_read_b64_tr_b16 v[194:195], v9 offset:8
    v_exp_f32 v102, v102
    v_exp_f32 v103, v103
    v_exp_f32 v104, v104
    v_mfma_f32_4x4x4_16b_bf16 v[208:211], v[178:179], v[178:179], v[208:211]
    v_exp_f32 v105, v105
    v_mfma_f32_32x32x16_bf16 v[64:79], v[132:135], v[24:27], v[64:79]
    s_setprio 2
    ds_read_b64_tr_b16 v[168:169], v5 offset:22528
    ds_read_b64_tr_b16 v[196:197], v9 offset:16
    v_exp_f32 v106, v106
    v_exp_f32 v107, v107
    v_exp_f32 v108, v108
    v_mfma_f32_4x4x4_16b_bf16 v[208:211], v[180:181], v[180:181], v[208:211]
    v_exp_f32 v109, v109
    v_smfmac_f32_32x32x32_bf16 v[32:47], v[152:155], v[96:103], v6
    ds_read_b64_tr_b16 v[170:171], v5 offset:22784
    ds_read_b64_tr_b16 v[198:199], v9 offset:24
    v_exp_f32 v110, v110
    v_exp_f32 v111, v111
    v_mfma_f32_4x4x4_16b_bf16 v[208:211], v[182:183], v[182:183], v[208:211]
    v_exp_f32 v112, v112
    v_exp_f32 v113, v113
    v_smfmac_f32_32x32x32_bf16 v[32:47], v[156:159], v[104:111], v6
    s_setprio 1
    ds_read_b64_tr_b16 v[172:173], v5 offset:23552
    v_exp_f32 v114, v114
    v_exp_f32 v115, v115
    v_mfma_f32_4x4x4_16b_bf16 v[208:211], v[184:185], v[184:185], v[208:211]
    v_exp_f32 v116, v116
    ds_read_b64_tr_b16 v[200:201], v9 offset:32
    v_exp_f32 v117, v117
    v_mfma_f32_32x32x16_bf16 v[80:95], v[128:131], v[20:23], 0
    ds_read_b64_tr_b16 v[202:203], v9 offset:40
    v_exp_f32 v118, v118
    v_exp_f32 v119, v119
    v_exp_f32 v120, v120
    v_mfma_f32_4x4x4_16b_bf16 v[208:211], v[186:187], v[186:187], v[208:211]
    v_exp_f32 v121, v121
    v_mfma_f32_32x32x16_bf16 v[80:95], v[132:135], v[28:31], v[80:95]
    ds_read_b64_tr_b16 v[174:175], v5 offset:23808
    s_setprio 0
    ds_read_b64_tr_b16 v[204:205], v9 offset:48
    ds_read_b32 v245, v244
    v_exp_f32 v122, v122
    v_exp_f32 v123, v123
    v_mfma_f32_4x4x4_16b_bf16 v[208:211], v[188:189], v[188:189], v[208:211]
    v_exp_f32 v124, v124
    v_exp_f32 v125, v125
    v_exp_f32 v126, v126
    v_smfmac_f32_32x32x32_bf16 v[48:63], v[152:155], v[112:119], v6
    v_exp_f32 v127, v127
    v_exp_f32 v64, v64
    s_waitcnt lgkmcnt(0)
    v_exp_f32 v65, v65
    v_smfmac_f32_32x32x32_bf16 v[48:63], v[156:159], v[120:127], v6
    s_setprio 3
    v_cmp_ge_u32 vcc, 1, v245
    s_cbranch_vccnz L_spinq1
L_backq1:
    ds_read_b128 v[128:131], v4 offset:32768
    v_exp_f32 v66, v66
    v_exp_f32 v67, v67
    v_cndmask_b32 v14, v208, v209, s[64:65]
    v_exp_f32 v68, v68
    ds_read_b128 v[132:135], v4 offset:33792
    v_cndmask_b32 v14, v14, v210, s[66:67]
    v_cndmask_b32 v14, v14, v211, s[68:69]
    v_exp_f32 v69, v69
    v_sqrt_f32 v14, v14
    v_exp_f32 v70, v70
    v_add_f32 v14, s44, v14
    v_mfma_f32_32x32x16_bf16 v[96:111], v[136:139], v[16:19], 0
    v_exp_f32 v71, v71
    v_exp_f32 v72, v72
    v_rcp_f32 v15, v14
    v_exp_f32 v73, v73
    v_mfma_f32_32x32x16_bf16 v[96:111], v[140:143], v[24:27], v[96:111]
    ds_read_b64_tr_b16 v[144:145], v5 offset:32768
    v_exp_f32 v74, v74
    v_cvt_pk_bf16_f32 v15, v15, v15
    v_and_b32 v206, v15, v10
    v_and_b32 v207, v15, v11
    v_exp_f32 v75, v75
    v_exp_f32 v76, v76
    v_mfma_f32_4x4x4_16b_bf16 v[208:211], v[192:193], v[206:207], 0
    v_exp_f32 v77, v77
    v_smfmac_f32_32x32x32_bf16 v[32:47], v[160:163], v[64:71], v6
    ds_read_b64_tr_b16 v[146:147], v5 offset:33024
    v_exp_f32 v78, v78
    v_exp_f32 v79, v79
    v_exp_f32 v80, v80
    v_exp_f32 v81, v81
    v_mfma_f32_4x4x4_16b_bf16 v[212:215], v[194:195], v[206:207], 0
    ds_read_b64_tr_b16 v[148:149], v5 offset:33792
    v_smfmac_f32_32x32x32_bf16 v[32:47], v[164:167], v[72:79], v6
    v_exp_f32 v82, v82
    v_exp_f32 v83, v83
    v_cvt_pk_bf16_f32 v176, v208, v209
    v_exp_f32 v84, v84
    v_mfma_f32_4x4x4_16b_bf16 v[216:219], v[196:197], v[206:207], 0
    v_cvt_pk_bf16_f32 v177, v210, v211
    v_exp_f32 v85, v85
    v_mfma_f32_32x32x16_bf16 v[112:127], v[136:139], v[20:23], 0
    ds_read_b64_tr_b16 v[150:151], v5 offset:34048
    v_exp_f32 v86, v86
    v_cvt_pk_bf16_f32 v178, v212, v213
    v_exp_f32 v87, v87
    v_exp_f32 v88, v88
    v_mfma_f32_4x4x4_16b_bf16 v[220:223], v[198:199], v[206:207], 0
    v_cvt_pk_bf16_f32 v179, v214, v215
    v_cvt_pk_bf16_f32 v180, v216, v217
    v_exp_f32 v89, v89
    v_mfma_f32_32x32x16_bf16 v[112:127], v[140:143], v[28:31], v[112:127]
    v_exp_f32 v90, v90
    v_exp_f32 v91, v91
    v_exp_f32 v92, v92
    v_mfma_f32_4x4x4_16b_bf16 v[224:227], v[200:201], v[206:207], 0
    v_exp_f32 v93, v93
    v_smfmac_f32_32x32x32_bf16 v[48:63], v[160:163], v[80:87], v6
    v_exp_f32 v94, v94
    s_waitcnt lgkmcnt(4)
    v_exp_f32 v95, v95
    v_cvt_pk_bf16_f32 v181, v218, v219
    v_cvt_pk_bf16_f32 v182, v220, v221
    ds_read_b128 v[136:139], v4 offset:34816
    v_exp_f32 v96, v96
    v_mfma_f32_4x4x4_16b_bf16 v[228:231], v[202:203], v[206:207], 0
    v_mfma_f32_4x4x4_16b_bf16 v[232:235], v[204:205], v[206:207], 0
    v_exp_f32 v97, v97
    v_smfmac_f32_32x32x32_bf16 v[48:63], v[164:167], v[88:95], v6
    s_setprio 2
    v_cvt_pk_bf16_f32 v183, v222, v223
    v_exp_f32 v98, v98
    v_exp_f32 v99, v99
    v_exp_f32 v100, v100
    v_cvt_pk_bf16_f32 v184, v224, v225
    v_mfma_f32_32x32x16_bf16 v[64:79], v[128:131], v[16:19], 0
    v_exp_f32 v101, v101
    ds_read_b128 v[140:143], v4 offset:35840
    ds_write_b128 v3, v[176:179] offset:32768
    v_exp_f32 v102, v102
    v_cvt_pk_bf16_f32 v185, v226, v227
    v_cvt_pk_bf16_f32 v186, v228, v229
    v_exp_f32 v103, v103
    v_exp_f32 v104, v104
    v_exp_f32 v105, v105
    v_mfma_f32_32x32x16_bf16 v[64:79], v[132:135], v[24:27], v[64:79]
    ds_write_b128 v3, v[180:183] offset:33280
    ds_read_b64_tr_b16 v[152:153], v5 offset:34816
    v_cvt_pk_bf16_f32 v187, v230, v231
    v_cvt_pk_bf16_f32 v188, v232, v233
    v_exp_f32 v106, v106
    v_exp_f32 v107, v107
    v_exp_f32 v108, v108
    v_exp_f32 v109, v109
    v_smfmac_f32_32x32x32_bf16 v[32:47], v[168:171], v[96:103], v6
    s_add_u32 s39, s39, 14336
    ds_read_b64_tr_b16 v[154:155], v5 offset:35072
    v_exp_f32 v110, v110
    v_cvt_pk_bf16_f32 v189, v234, v235
    v_exp_f32 v111, v111
    v_exp_f32 v112, v112
    v_exp_f32 v113, v113
    v_smfmac_f32_32x32x32_bf16 v[32:47], v[172:175], v[104:111], v6
    s_setprio 1
    ds_read_b64_tr_b16 v[156:157], v5 offset:35840
    ds_write_b128 v3, v[184:187] offset:33792
    v_exp_f32 v114, v114
    v_exp_f32 v115, v115
    v_exp_f32 v116, v116
    v_exp_f32 v117, v117
    v_mfma_f32_32x32x16_bf16 v[80:95], v[128:131], v[20:23], 0
    ds_write_b128 v3, v[188:191] offset:34304
    v_exp_f32 v118, v118
    v_exp_f32 v119, v119
    v_exp_f32 v120, v120
    v_exp_f32 v121, v121
    v_mfma_f32_32x32x16_bf16 v[80:95], v[132:135], v[28:31], v[80:95]
    s_setprio 0
    ds_read_b64_tr_b16 v[158:159], v5 offset:36096
    v_exp_f32 v122, v122
    v_exp_f32 v123, v123
    v_smfmac_f32_32x32x32_bf16 v[48:63], v[168:171], v[112:119], v6
    v_exp_f32 v124, v124
    v_exp_f32 v125, v125
    s_waitcnt vmcnt(0)
    ds_add_u32 v243, v246
    v_exp_f32 v126, v126
    v_exp_f32 v127, v127
    v_exp_f32 v64, v64
    v_exp_f32 v65, v65
    v_smfmac_f32_32x32x32_bf16 v[48:63], v[172:175], v[120:127], v6
    ds_read_b128 v[128:131], v4 offset:36864
    s_waitcnt lgkmcnt(10)
    v_exp_f32 v66, v66
    v_exp_f32 v67, v67
    v_mfma_f32_32x32x16_bf16 v[96:111], v[136:139], v[16:19], 0
    s_setprio 3
    v_exp_f32 v68, v68
    v_exp_f32 v69, v69
    ds_read_b128 v[132:135], v4 offset:37888
    v_exp_f32 v70, v70
    v_exp_f32 v71, v71
    v_exp_f32 v72, v72
    v_exp_f32 v73, v73
    v_mfma_f32_32x32x16_bf16 v[96:111], v[140:143], v[24:27], v[96:111]
    s_add_u32 m0, s40, 0xffffc000
    s_mov_b64 exec, s[52:53]
    buffer_load_dwordx4 v2, s[24:27], s39 offen lds
    s_mov_b64 exec, -1
    v_exp_f32 v74, v74
    ds_read_b64_tr_b16 v[160:161], v5 offset:36864
    v_exp_f32 v75, v75
    v_exp_f32 v76, v76
    v_exp_f32 v77, v77
    v_smfmac_f32_32x32x32_bf16 v[32:47], v[144:147], v[64:71], v6
    s_add_u32 m0, s40, 0xffffc080
    s_mov_b64 exec, s[52:53]
    buffer_load_dwordx4 v2, s[24:27], s39 offen offset:896 lds
    s_mov_b64 exec, -1
    ds_read_b64_tr_b16 v[162:163], v5 offset:37120
    v_exp_f32 v78, v78
    v_exp_f32 v79, v79
    v_exp_f32 v80, v80
    v_exp_f32 v81, v81
    v_smfmac_f32_32x32x32_bf16 v[32:47], v[148:151], v[72:79], v6
    v_exp_f32 v82, v82
    v_exp_f32 v83, v83
    v_exp_f32 v84, v84
    v_exp_f32 v85, v85
    v_mfma_f32_32x32x16_bf16 v[112:127], v[136:139], v[20:23], 0
    ds_read_b64_tr_b16 v[164:165], v5 offset:37888
    ds_read_b64_tr_b16 v[166:167], v5 offset:38144
    v_exp_f32 v86, v86
    v_exp_f32 v87, v87
    v_exp_f32 v88, v88
    v_exp_f32 v89, v89
    v_exp_f32 v90, v90
    v_mfma_f32_32x32x16_bf16 v[112:127], v[140:143], v[28:31], v[112:127]
    s_mov_b32 m0, s41
    s_nop 0
    buffer_load_dwordx4 v1, s[20:23], s38 offen offset:0 lds
    v_exp_f32 v91, v91
    buffer_load_dwordx4 v1, s[20:23], s38 offen offset:1024 lds
    v_exp_f32 v92, v92
    v_exp_f32 v93, v93
    v_smfmac_f32_32x32x32_bf16 v[48:63], v[144:147], v[80:87], v6
    buffer_load_dwordx4 v1, s[20:23], s38 offen offset:2048 lds
    v_exp_f32 v94, v94
    v_exp_f32 v95, v95
    s_mov_b32 exec_hi, 0
    buffer_load_dwordx4 v1, s[20:23], s38 offen offset:3072 lds
    s_mov_b32 exec_hi, -1
    s_add_u32 s38, s38, 28672
    v_exp_f32 v96, v96
    v_exp_f32 v97, v97
    v_smfmac_f32_32x32x32_bf16 v[48:63], v[148:151], v[88:95], v6
    s_waitcnt lgkmcnt(4)
    ds_read_b128 v[136:139], v4 offset:38912
    v_exp_f32 v98, v98
    s_setprio 2
    v_exp_f32 v99, v99
    v_exp_f32 v100, v100
    v_exp_f32 v101, v101
    v_mfma_f32_32x32x16_bf16 v[64:79], v[128:131], v[16:19], 0
    ds_read_b128 v[140:143], v4 offset:39936
    v_exp_f32 v102, v102
    v_exp_f32 v103, v103
    v_exp_f32 v104, v104
    v_exp_f32 v105, v105
    v_mfma_f32_32x32x16_bf16 v[64:79], v[132:135], v[24:27], v[64:79]
    s_setprio 2
    ds_read_b64_tr_b16 v[168:169], v5 offset:38912
    v_exp_f32 v106, v106
    v_exp_f32 v107, v107
    v_exp_f32 v108, v108
    v_exp_f32 v109, v109
    v_smfmac_f32_32x32x32_bf16 v[32:47], v[152:155], v[96:103], v6
    ds_read_b64_tr_b16 v[170:171], v5 offset:39168
    v_exp_f32 v110, v110
    v_exp_f32 v111, v111
    v_exp_f32 v112, v112
    v_exp_f32 v113, v113
    v_smfmac_f32_32x32x32_bf16 v[32:47], v[156:159], v[104:111], v6
    ds_read_b64_tr_b16 v[172:173], v5 offset:39936
    v_exp_f32 v114, v114
    s_setprio 1
    v_exp_f32 v115, v115
    v_exp_f32 v116, v116
    v_exp_f32 v117, v117
    v_mfma_f32_32x32x16_bf16 v[80:95], v[128:131], v[20:23], 0
    ds_read_b64_tr_b16 v[174:175], v5 offset:40192
    v_exp_f32 v118, v118
    v_exp_f32 v119, v119
    v_exp_f32 v120, v120
    v_exp_f32 v121, v121
    s_setprio 0
    v_mfma_f32_32x32x16_bf16 v[80:95], v[132:135], v[28:31], v[80:95]
    v_exp_f32 v122, v122
    ds_read_b32 v245, v244
    v_exp_f32 v123, v123
    v_exp_f32 v124, v124
    v_exp_f32 v125, v125
    v_exp_f32 v126, v126
    v_exp_f32 v127, v127
    v_smfmac_f32_32x32x32_bf16 v[48:63], v[152:155], v[112:119], v6
    v_exp_f32 v64, v64
    v_exp_f32 v65, v65
    v_smfmac_f32_32x32x32_bf16 v[48:63], v[156:159], v[120:127], v6
    s_waitcnt lgkmcnt(0)
    v_cmp_ge_u32 vcc, 2, v245
    s_cbranch_vccnz L_spinq2
L_backq2:
    s_setprio 3
    v_exp_f32 v66, v66
    v_exp_f32 v67, v67
    v_exp_f32 v68, v68
    v_exp_f32 v69, v69
    v_mfma_f32_32x32x16_bf16 v[96:111], v[136:139], v[16:19], 0
    ds_read_b128 v[128:131], v4 offset:49152
    v_exp_f32 v70, v70
    ds_read_b128 v[132:135], v4 offset:50176
    v_exp_f32 v71, v71
    v_exp_f32 v72, v72
    v_exp_f32 v73, v73
    ds_read_b64_tr_b16 v[144:145], v5 offset:49152
    v_exp_f32 v74, v74
    v_mfma_f32_32x32x16_bf16 v[96:111], v[140:143], v[24:27], v[96:111]
    v_exp_f32 v75, v75
    v_exp_f32 v76, v76
    v_exp_f32 v77, v77
    v_smfmac_f32_32x32x32_bf16 v[32:47], v[160:163], v[64:71], v6
    ds_read_b64_tr_b16 v[146:147], v5 offset:49408
    v_exp_f32 v78, v78
    v_exp_f32 v79, v79
    v_exp_f32 v80, v80
    v_exp_f32 v81, v81
    v_smfmac_f32_32x32x32_bf16 v[32:47], v[164:167], v[72:79], v6
    v_exp_f32 v82, v82
    ds_read_b64_tr_b16 v[148:149], v5 offset:50176
    v_exp_f32 v83, v83
    v_exp_f32 v84, v84
    v_exp_f32 v85, v85
    v_mfma_f32_32x32x16_bf16 v[112:127], v[136:139], v[20:23], 0
    ds_read_b64_tr_b16 v[150:151], v5 offset:50432
    v_exp_f32 v86, v86
    v_exp_f32 v87, v87
    v_exp_f32 v88, v88
    v_exp_f32 v89, v89
    v_mfma_f32_32x32x16_bf16 v[112:127], v[140:143], v[28:31], v[112:127]
    v_exp_f32 v90, v90
    v_exp_f32 v91, v91
    v_exp_f32 v92, v92
    v_exp_f32 v93, v93
    v_smfmac_f32_32x32x32_bf16 v[48:63], v[160:163], v[80:87], v6
    v_exp_f32 v94, v94
    v_exp_f32 v95, v95
    v_exp_f32 v96, v96
    s_waitcnt lgkmcnt(4)
    v_exp_f32 v97, v97
    v_smfmac_f32_32x32x32_bf16 v[48:63], v[164:167], v[88:95], v6
    s_setprio 2
    ds_read_b128 v[136:139], v4 offset:51200
    v_exp_f32 v98, v98
    v_exp_f32 v99, v99
    v_exp_f32 v100, v100
    v_exp_f32 v101, v101
    v_mfma_f32_32x32x16_bf16 v[64:79], v[128:131], v[16:19], 0
    v_exp_f32 v102, v102
    v_exp_f32 v103, v103
    v_exp_f32 v104, v104
    v_exp_f32 v105, v105
    v_mfma_f32_32x32x16_bf16 v[64:79], v[132:135], v[24:27], v[64:79]
    ds_read_b128 v[140:143], v4 offset:52224
    ds_read_b64_tr_b16 v[152:153], v5 offset:51200
    v_exp_f32 v106, v106
    v_exp_f32 v107, v107
    v_exp_f32 v108, v108
    v_exp_f32 v109, v109
    v_smfmac_f32_32x32x32_bf16 v[32:47], v[168:171], v[96:103], v6
    s_setprio 1
    s_add_u32 s39, s39, 14336
    ds_read_b64_tr_b16 v[154:155], v5 offset:51456
    v_exp_f32 v110, v110
    v_exp_f32 v111, v111
    v_exp_f32 v112, v112
    v_exp_f32 v113, v113
    ds_read_b64_tr_b16 v[156:157], v5 offset:52224
    v_exp_f32 v114, v114
    v_exp_f32 v115, v115
    v_smfmac_f32_32x32x32_bf16 v[32:47], v[172:175], v[104:111], v6
    v_exp_f32 v116, v116
    v_exp_f32 v117, v117
    v_mfma_f32_32x32x16_bf16 v[80:95], v[128:131], v[20:23], 0
    s_setprio 0
    v_exp_f32 v118, v118
    v_exp_f32 v119, v119
    ds_read_b64_tr_b16 v[158:159], v5 offset:52480
    v_exp_f32 v120, v120
    v_exp_f32 v121, v121
    v_mfma_f32_32x32x16_bf16 v[80:95], v[132:135], v[28:31], v[80:95]
    v_exp_f32 v122, v122
    v_exp_f32 v123, v123
    v_exp_f32 v124, v124
    v_exp_f32 v125, v125
    v_smfmac_f32_32x32x32_bf16 v[48:63], v[168:171], v[112:119], v6
    s_waitcnt vmcnt(0)
    ds_add_u32 v243, v246
    v_exp_f32 v126, v126
    v_exp_f32 v127, v127
    v_exp_f32 v64, v64
    v_exp_f32 v65, v65
    v_smfmac_f32_32x32x32_bf16 v[48:63], v[172:175], v[120:127], v6
    s_setprio 3
    ds_read_b128 v[128:131], v4 offset:53248
    s_waitcnt lgkmcnt(6)
    v_exp_f32 v66, v66
    v_exp_f32 v67, v67
    v_exp_f32 v68, v68
    v_exp_f32 v69, v69
    v_mfma_f32_32x32x16_bf16 v[96:111], v[136:139], v[16:19], 0
    v_exp_f32 v70, v70
    v_exp_f32 v71, v71
    v_exp_f32 v72, v72
    v_exp_f32 v73, v73
    ds_read_b128 v[132:135], v4 offset:54272
    v_mfma_f32_32x32x16_bf16 v[96:111], v[140:143], v[24:27], v[96:111]
    ds_read_b64_tr_b16 v[160:161], v5 offset:53248
    v_exp_f32 v74, v74
    v_exp_f32 v75, v75
    s_add_u32 m0, s40, 0x0
    s_mov_b64 exec, s[52:53]
    buffer_load_dwordx4 v2, s[24:27], s39 offen lds
    s_mov_b64 exec, -1
    v_exp_f32 v76, v76
    v_exp_f32 v77, v77
    v_smfmac_f32_32x32x32_bf16 v[32:47], v[144:147], v[64:71], v6
    ds_read_b64_tr_b16 v[162:163], v5 offset:53504
    v_exp_f32 v78, v78
    s_add_u32 m0, s40, 0x80
    s_mov_b64 exec, s[52:53]
    buffer_load_dwordx4 v2, s[24:27], s39 offen offset:896 lds
    s_mov_b64 exec, -1
    v_exp_f32 v79, v79
    v_exp_f32 v80, v80
    v_exp_f32 v81, v81
    v_smfmac_f32_32x32x32_bf16 v[32:47], v[148:151], v[72:79], v6
    ds_read_b64_tr_b16 v[164:165], v5 offset:54272
    ds_read2_b64 v[176:179], v8 offset0:0 offset1:1
    v_exp_f32 v82, v82
    v_exp_f32 v83, v83
    v_exp_f32 v84, v84
    v_mfma_f32_32x32x16_bf16 v[112:127], v[136:139], v[20:23], 0
    v_exp_f32 v85, v85
    ds_read_b64_tr_b16 v[166:167], v5 offset:54528
    ds_read2_b64 v[180:183], v8 offset0:2 offset1:3
    v_mfma_f32_32x32x16_bf16 v[112:127], v[140:143], v[28:31], v[112:127]
    v_exp_f32 v86, v86
    v_exp_f32 v87, v87
    v_exp_f32 v88, v88
    ds_read2_b64 v[184:187], v8 offset0:4 offset1:5
    v_exp_f32 v89, v89
    v_exp_f32 v90, v90
    v_exp_f32 v91, v91
    v_exp_f32 v92, v92
    v_exp_f32 v93, v93
    v_smfmac_f32_32x32x32_bf16 v[48:63], v[144:147], v[80:87], v6
    s_setprio 2
    ds_read_b64 v[188:189], v8 offset:48
    v_exp_f32 v94, v94
    v_exp_f32 v95, v95
    v_exp_f32 v96, v96
    v_exp_f32 v97, v97
    v_smfmac_f32_32x32x32_bf16 v[48:63], v[148:151], v[88:95], v6
    ds_read_b128 v[136:139], v4 offset:55296
    s_waitcnt lgkmcnt(1)
    ds_read_b64_tr_b16 v[192:193], v9 offset:0
    v_exp_f32 v98, v98
    v_exp_f32 v99, v99
    v_exp_f32 v100, v100
    v_mfma_f32_4x4x4_16b_bf16 v[208:211], v[176:177], v[176:177], 0
    v_exp_f32 v101, v101
    v_mfma_f32_32x32x16_bf16 v[64:79], v[128:131], v[16:19], 0
    ds_read_b128 v[140:143], v4 offset:56320
    ds_read_b64_tr_b16 v[194:195], v9 offset:8
    v_exp_f32 v102, v102
    v_exp_f32 v103, v103
    v_exp_f32 v104, v104
    v_mfma_f32_4x4x4_16b_bf16 v[208:211], v[178:179], v[178:179], v[208:211]
    v_exp_f32 v105, v105
    v_mfma_f32_32x32x16_bf16 v[64:79], v[132:135], v[24:27], v[64:79]
    s_setprio 2
    ds_read_b64_tr_b16 v[168:169], v5 offset:55296
    ds_read_b64_tr_b16 v[196:197], v9 offset:16
    v_exp_f32 v106, v106
    v_exp_f32 v107, v107
    v_exp_f32 v108, v108
    v_mfma_f32_4x4x4_16b_bf16 v[208:211], v[180:181], v[180:181], v[208:211]
    v_exp_f32 v109, v109
    v_smfmac_f32_32x32x32_bf16 v[32:47], v[152:155], v[96:103], v6
    ds_read_b64_tr_b16 v[170:171], v5 offset:55552
    ds_read_b64_tr_b16 v[198:199], v9 offset:24
    v_exp_f32 v110, v110
    v_exp_f32 v111, v111
    v_mfma_f32_4x4x4_16b_bf16 v[208:211], v[182:183], v[182:183], v[208:211]
    v_exp_f32 v112, v112
    v_exp_f32 v113, v113
    v_smfmac_f32_32x32x32_bf16 v[32:47], v[156:159], v[104:111], v6
    s_setprio 1
    ds_read_b64_tr_b16 v[172:173], v5 offset:56320
    v_exp_f32 v114, v114
    v_exp_f32 v115, v115
    v_mfma_f32_4x4x4_16b_bf16 v[208:211], v[184:185], v[184:185], v[208:211]
    v_exp_f32 v116, v116
    ds_read_b64_tr_b16 v[200:201], v9 offset:32
    v_exp_f32 v117, v117
    v_mfma_f32_32x32x16_bf16 v[80:95], v[128:131], v[20:23], 0
    ds_read_b64_tr_b16 v[202:203], v9 offset:40
    v_exp_f32 v118, v118
    v_exp_f32 v119, v119
    v_exp_f32 v120, v120
    v_mfma_f32_4x4x4_16b_bf16 v[208:211], v[186:187], v[186:187], v[208:211]
    v_exp_f32 v121, v121
    v_mfma_f32_32x32x16_bf16 v[80:95], v[132:135], v[28:31], v[80:95]
    ds_read_b64_tr_b16 v[174:175], v5 offset:56576
    s_setprio 0
    ds_read_b64_tr_b16 v[204:205], v9 offset:48
    ds_read_b32 v245, v244
    v_exp_f32 v122, v122
    v_exp_f32 v123, v123
    v_mfma_f32_4x4x4_16b_bf16 v[208:211], v[188:189], v[188:189], v[208:211]
    v_exp_f32 v124, v124
    v_exp_f32 v125, v125
    v_exp_f32 v126, v126
    v_smfmac_f32_32x32x32_bf16 v[48:63], v[152:155], v[112:119], v6
    v_exp_f32 v127, v127
    v_exp_f32 v64, v64
    s_waitcnt lgkmcnt(0)
    v_exp_f32 v65, v65
    v_smfmac_f32_32x32x32_bf16 v[48:63], v[156:159], v[120:127], v6
    s_setprio 3
    v_cmp_ge_u32 vcc, 3, v245
    s_cbranch_vccnz L_spinq3
L_backq3:
    ds_read_b128 v[128:131], v4 offset:0
    v_exp_f32 v66, v66
    v_exp_f32 v67, v67
    v_cndmask_b32 v14, v208, v209, s[64:65]
    v_exp_f32 v68, v68
    ds_read_b128 v[132:135], v4 offset:1024
    v_cndmask_b32 v14, v14, v210, s[66:67]
    v_cndmask_b32 v14, v14, v211, s[68:69]
    v_exp_f32 v69, v69
    v_sqrt_f32 v14, v14
    v_exp_f32 v70, v70
    v_add_f32 v14, s44, v14
    v_mfma_f32_32x32x16_bf16 v[96:111], v[136:139], v[16:19], 0
    v_exp_f32 v71, v71
    v_exp_f32 v72, v72
    v_rcp_f32 v15, v14
    v_exp_f32 v73, v73
    v_mfma_f32_32x32x16_bf16 v[96:111], v[140:143], v[24:27], v[96:111]
    ds_read_b64_tr_b16 v[144:145], v5 offset:0
    v_exp_f32 v74, v74
    v_cvt_pk_bf16_f32 v15, v15, v15
    v_and_b32 v206, v15, v10
    v_and_b32 v207, v15, v11
    v_exp_f32 v75, v75
    v_exp_f32 v76, v76
    v_mfma_f32_4x4x4_16b_bf16 v[208:211], v[192:193], v[206:207], 0
    v_exp_f32 v77, v77
    v_smfmac_f32_32x32x32_bf16 v[32:47], v[160:163], v[64:71], v6
    ds_read_b64_tr_b16 v[146:147], v5 offset:256
    v_exp_f32 v78, v78
    v_exp_f32 v79, v79
    v_exp_f32 v80, v80
    v_exp_f32 v81, v81
    v_mfma_f32_4x4x4_16b_bf16 v[212:215], v[194:195], v[206:207], 0
    ds_read_b64_tr_b16 v[148:149], v5 offset:1024
    v_smfmac_f32_32x32x32_bf16 v[32:47], v[164:167], v[72:79], v6
    v_exp_f32 v82, v82
    v_exp_f32 v83, v83
    v_cvt_pk_bf16_f32 v176, v208, v209
    v_exp_f32 v84, v84
    v_mfma_f32_4x4x4_16b_bf16 v[216:219], v[196:197], v[206:207], 0
    v_cvt_pk_bf16_f32 v177, v210, v211
    v_exp_f32 v85, v85
    v_mfma_f32_32x32x16_bf16 v[112:127], v[136:139], v[20:23], 0
    ds_read_b64_tr_b16 v[150:151], v5 offset:1280
    v_exp_f32 v86, v86
    v_cvt_pk_bf16_f32 v178, v212, v213
    v_exp_f32 v87, v87
    v_exp_f32 v88, v88
    v_mfma_f32_4x4x4_16b_bf16 v[220:223], v[198:199], v[206:207], 0
    v_cvt_pk_bf16_f32 v179, v214, v215
    v_cvt_pk_bf16_f32 v180, v216, v217
    v_exp_f32 v89, v89
    v_mfma_f32_32x32x16_bf16 v[112:127], v[140:143], v[28:31], v[112:127]
    v_exp_f32 v90, v90
    v_exp_f32 v91, v91
    v_exp_f32 v92, v92
    v_mfma_f32_4x4x4_16b_bf16 v[224:227], v[200:201], v[206:207], 0
    v_exp_f32 v93, v93
    v_smfmac_f32_32x32x32_bf16 v[48:63], v[160:163], v[80:87], v6
    v_exp_f32 v94, v94
    v_exp_f32 v95, v95
    v_cvt_pk_bf16_f32 v181, v218, v219
    v_cvt_pk_bf16_f32 v182, v220, v221
    ds_read_b128 v[136:139], v4 offset:2048
    v_exp_f32 v96, v96
    v_mfma_f32_4x4x4_16b_bf16 v[228:231], v[202:203], v[206:207], 0
    v_mfma_f32_4x4x4_16b_bf16 v[232:235], v[204:205], v[206:207], 0
    v_exp_f32 v97, v97
    v_smfmac_f32_32x32x32_bf16 v[48:63], v[164:167], v[88:95], v6
    s_waitcnt lgkmcnt(5)
    s_setprio 2
    v_cvt_pk_bf16_f32 v183, v222, v223
    v_exp_f32 v98, v98
    v_exp_f32 v99, v99
    v_exp_f32 v100, v100
    v_cvt_pk_bf16_f32 v184, v224, v225
    v_mfma_f32_32x32x16_bf16 v[64:79], v[128:131], v[16:19], 0
    v_exp_f32 v101, v101
    ds_read_b128 v[140:143], v4 offset:3072
    ds_write_b128 v3, v[176:179] offset:0
    v_exp_f32 v102, v102
    v_cvt_pk_bf16_f32 v185, v226, v227
    v_cvt_pk_bf16_f32 v186, v228, v229
    v_exp_f32 v103, v103
    v_exp_f32 v104, v104
    v_exp_f32 v105, v105
    v_mfma_f32_32x32x16_bf16 v[64:79], v[132:135], v[24:27], v[64:79]
    ds_write_b128 v3, v[180:183] offset:512
    ds_read_b64_tr_b16 v[152:153], v5 offset:2048
    v_cvt_pk_bf16_f32 v187, v230, v231
    v_cvt_pk_bf16_f32 v188, v232, v233
    v_exp_f32 v106, v106
    v_exp_f32 v107, v107
    v_exp_f32 v108, v108
    v_exp_f32 v109, v109
    v_smfmac_f32_32x32x32_bf16 v[32:47], v[168:171], v[96:103], v6
    s_add_u32 s39, s39, 14336
    ds_read_b64_tr_b16 v[154:155], v5 offset:2304
    v_exp_f32 v110, v110
    v_cvt_pk_bf16_f32 v189, v234, v235
    v_exp_f32 v111, v111
    v_exp_f32 v112, v112
    v_exp_f32 v113, v113
    v_smfmac_f32_32x32x32_bf16 v[32:47], v[172:175], v[104:111], v6
    s_setprio 1
    ds_read_b64_tr_b16 v[156:157], v5 offset:3072
    ds_write_b128 v3, v[184:187] offset:1024
    v_exp_f32 v114, v114
    v_exp_f32 v115, v115
    v_exp_f32 v116, v116
    v_exp_f32 v117, v117
    v_mfma_f32_32x32x16_bf16 v[80:95], v[128:131], v[20:23], 0
    ds_write_b128 v3, v[188:191] offset:1536
    v_exp_f32 v118, v118
    v_exp_f32 v119, v119
    v_exp_f32 v120, v120
    v_exp_f32 v121, v121
    v_mfma_f32_32x32x16_bf16 v[80:95], v[132:135], v[28:31], v[80:95]
    s_setprio 0
    ds_read_b64_tr_b16 v[158:159], v5 offset:3328
    v_exp_f32 v122, v122
    v_exp_f32 v123, v123
    v_smfmac_f32_32x32x32_bf16 v[48:63], v[168:171], v[112:119], v6
    v_exp_f32 v124, v124
    v_exp_f32 v125, v125
    s_waitcnt vmcnt(0)
    ds_add_u32 v243, v246
    v_exp_f32 v126, v126
    v_exp_f32 v127, v127
    v_exp_f32 v64, v64
    v_exp_f32 v65, v65
    v_smfmac_f32_32x32x32_bf16 v[48:63], v[172:175], v[120:127], v6
    ds_read_b128 v[128:131], v4 offset:4096
    s_waitcnt lgkmcnt(10)
    v_exp_f32 v66, v66
    v_exp_f32 v67, v67
    v_mfma_f32_32x32x16_bf16 v[96:111], v[136:139], v[16:19], 0
    s_setprio 3
    v_exp_f32 v68, v68
    v_exp_f32 v69, v69
    ds_read_b128 v[132:135], v4 offset:5120
    v_exp_f32 v70, v70
    v_exp_f32 v71, v71
    v_exp_f32 v72, v72
    v_exp_f32 v73, v73
    v_mfma_f32_32x32x16_bf16 v[96:111], v[140:143], v[24:27], v[96:111]
    s_add_u32 m0, s40, 0x4000
    s_mov_b64 exec, s[52:53]
    buffer_load_dwordx4 v2, s[24:27], s39 offen lds
    s_mov_b64 exec, -1
    v_exp_f32 v74, v74
    ds_read_b64_tr_b16 v[160:161], v5 offset:4096
    v_exp_f32 v75, v75
    v_exp_f32 v76, v76
    v_exp_f32 v77, v77
    v_smfmac_f32_32x32x32_bf16 v[32:47], v[144:147], v[64:71], v6
    s_add_u32 m0, s40, 0x4080
    s_mov_b64 exec, s[52:53]
    buffer_load_dwordx4 v2, s[24:27], s39 offen offset:896 lds
    s_mov_b64 exec, -1
    ds_read_b64_tr_b16 v[162:163], v5 offset:4352
    v_exp_f32 v78, v78
    v_exp_f32 v79, v79
    v_exp_f32 v80, v80
    v_exp_f32 v81, v81
    v_smfmac_f32_32x32x32_bf16 v[32:47], v[148:151], v[72:79], v6
    v_exp_f32 v82, v82
    v_exp_f32 v83, v83
    v_exp_f32 v84, v84
    v_exp_f32 v85, v85
    v_mfma_f32_32x32x16_bf16 v[112:127], v[136:139], v[20:23], 0
    ds_read_b64_tr_b16 v[164:165], v5 offset:5120
    ds_read_b64_tr_b16 v[166:167], v5 offset:5376
    v_exp_f32 v86, v86
    v_exp_f32 v87, v87
    v_exp_f32 v88, v88
    v_exp_f32 v89, v89
    v_exp_f32 v90, v90
    v_mfma_f32_32x32x16_bf16 v[112:127], v[140:143], v[28:31], v[112:127]
    s_mov_b32 m0, s41
    s_nop 0
    buffer_load_dwordx4 v1, s[20:23], s38 offen offset:0 lds
    v_exp_f32 v91, v91
    buffer_load_dwordx4 v1, s[20:23], s38 offen offset:1024 lds
    v_exp_f32 v92, v92
    v_exp_f32 v93, v93
    v_smfmac_f32_32x32x32_bf16 v[48:63], v[144:147], v[80:87], v6
    buffer_load_dwordx4 v1, s[20:23], s38 offen offset:2048 lds
    v_exp_f32 v94, v94
    v_exp_f32 v95, v95
    s_mov_b32 exec_hi, 0
    buffer_load_dwordx4 v1, s[20:23], s38 offen offset:3072 lds
    s_mov_b32 exec_hi, -1
    s_add_u32 s38, s38, 28672
    v_exp_f32 v96, v96
    v_exp_f32 v97, v97
    v_smfmac_f32_32x32x32_bf16 v[48:63], v[148:151], v[88:95], v6
    s_waitcnt lgkmcnt(4)
    ds_read_b128 v[136:139], v4 offset:6144
    v_exp_f32 v98, v98
    s_setprio 2
    v_exp_f32 v99, v99
    v_exp_f32 v100, v100
    v_exp_f32 v101, v101
    v_mfma_f32_32x32x16_bf16 v[64:79], v[128:131], v[16:19], 0
    ds_read_b128 v[140:143], v4 offset:7168
    v_exp_f32 v102, v102
    v_exp_f32 v103, v103
    v_exp_f32 v104, v104
    v_exp_f32 v105, v105
    v_mfma_f32_32x32x16_bf16 v[64:79], v[132:135], v[24:27], v[64:79]
    s_setprio 2
    ds_read_b64_tr_b16 v[168:169], v5 offset:6144
    v_exp_f32 v106, v106
    v_exp_f32 v107, v107
    v_exp_f32 v108, v108
    v_exp_f32 v109, v109
    v_smfmac_f32_32x32x32_bf16 v[32:47], v[152:155], v[96:103], v6
    ds_read_b64_tr_b16 v[170:171], v5 offset:6400
    v_exp_f32 v110, v110
    v_exp_f32 v111, v111
    v_exp_f32 v112, v112
    v_exp_f32 v113, v113
    v_smfmac_f32_32x32x32_bf16 v[32:47], v[156:159], v[104:111], v6
    ds_read_b64_tr_b16 v[172:173], v5 offset:7168
    v_exp_f32 v114, v114
    s_setprio 1
    v_exp_f32 v115, v115
    v_exp_f32 v116, v116
    v_exp_f32 v117, v117
    v_mfma_f32_32x32x16_bf16 v[80:95], v[128:131], v[20:23], 0
    ds_read_b64_tr_b16 v[174:175], v5 offset:7424
    v_exp_f32 v118, v118
    v_exp_f32 v119, v119
    v_exp_f32 v120, v120
    v_exp_f32 v121, v121
    s_setprio 0
    v_mfma_f32_32x32x16_bf16 v[80:95], v[132:135], v[28:31], v[80:95]
    v_exp_f32 v122, v122
    ds_read_b32 v245, v244
    v_exp_f32 v123, v123
    v_exp_f32 v124, v124
    v_exp_f32 v125, v125
    v_exp_f32 v126, v126
    v_exp_f32 v127, v127
    v_smfmac_f32_32x32x32_bf16 v[48:63], v[152:155], v[112:119], v6
    v_exp_f32 v64, v64
    v_exp_f32 v65, v65
    v_smfmac_f32_32x32x32_bf16 v[48:63], v[156:159], v[120:127], v6
    s_waitcnt lgkmcnt(0)
    v_cmp_ge_u32 vcc, 4, v245
    s_cbranch_vccnz L_spinq4
L_backq4:
    s_setprio 3
    v_exp_f32 v66, v66
    v_exp_f32 v67, v67
    v_exp_f32 v68, v68
    v_exp_f32 v69, v69
    v_mfma_f32_32x32x16_bf16 v[96:111], v[136:139], v[16:19], 0
    ds_read_b128 v[128:131], v4 offset:16384
    v_exp_f32 v70, v70
    ds_read_b128 v[132:135], v4 offset:17408
    v_exp_f32 v71, v71
    v_exp_f32 v72, v72
    v_exp_f32 v73, v73
    ds_read_b64_tr_b16 v[144:145], v5 offset:16384
    v_exp_f32 v74, v74
    v_mfma_f32_32x32x16_bf16 v[96:111], v[140:143], v[24:27], v[96:111]
    v_exp_f32 v75, v75
    v_exp_f32 v76, v76
    v_exp_f32 v77, v77
    v_smfmac_f32_32x32x32_bf16 v[32:47], v[160:163], v[64:71], v6
    ds_read_b64_tr_b16 v[146:147], v5 offset:16640
    v_exp_f32 v78, v78
    v_exp_f32 v79, v79
    v_exp_f32 v80, v80
    v_exp_f32 v81, v81
    v_smfmac_f32_32x32x32_bf16 v[32:47], v[164:167], v[72:79], v6
    v_exp_f32 v82, v82
    ds_read_b64_tr_b16 v[148:149], v5 offset:17408
    v_exp_f32 v83, v83
    v_exp_f32 v84, v84
    v_exp_f32 v85, v85
    v_mfma_f32_32x32x16_bf16 v[112:127], v[136:139], v[20:23], 0
    ds_read_b64_tr_b16 v[150:151], v5 offset:17664
    v_exp_f32 v86, v86
    v_exp_f32 v87, v87
    v_exp_f32 v88, v88
    v_exp_f32 v89, v89
    v_mfma_f32_32x32x16_bf16 v[112:127], v[140:143], v[28:31], v[112:127]
    v_exp_f32 v90, v90
    v_exp_f32 v91, v91
    v_exp_f32 v92, v92
    v_exp_f32 v93, v93
    v_smfmac_f32_32x32x32_bf16 v[48:63], v[160:163], v[80:87], v6
    v_exp_f32 v94, v94
    v_exp_f32 v95, v95
    v_exp_f32 v96, v96
    s_waitcnt lgkmcnt(4)
    v_exp_f32 v97, v97
    v_smfmac_f32_32x32x32_bf16 v[48:63], v[164:167], v[88:95], v6
    s_setprio 2
    ds_read_b128 v[136:139], v4 offset:18432
    v_exp_f32 v98, v98
    v_exp_f32 v99, v99
    v_exp_f32 v100, v100
    v_exp_f32 v101, v101
    v_mfma_f32_32x32x16_bf16 v[64:79], v[128:131], v[16:19], 0
    v_exp_f32 v102, v102
    v_exp_f32 v103, v103
    v_exp_f32 v104, v104
    v_exp_f32 v105, v105
    v_mfma_f32_32x32x16_bf16 v[64:79], v[132:135], v[24:27], v[64:79]
    ds_read_b128 v[140:143], v4 offset:19456
    ds_read_b64_tr_b16 v[152:153], v5 offset:18432
    v_exp_f32 v106, v106
    v_exp_f32 v107, v107
    v_exp_f32 v108, v108
    v_exp_f32 v109, v109
    v_smfmac_f32_32x32x32_bf16 v[32:47], v[168:171], v[96:103], v6
    s_setprio 1
    s_setprio 1
    s_add_u32 s39, s39, 14336
    ds_read_b64_tr_b16 v[154:155], v5 offset:18688
    v_exp_f32 v110, v110
    v_exp_f32 v111, v111
    v_exp_f32 v112, v112
    v_exp_f32 v113, v113
    ds_read_b64_tr_b16 v[156:157], v5 offset:19456
    v_exp_f32 v114, v114
    v_exp_f32 v115, v115
    v_smfmac_f32_32x32x32_bf16 v[32:47], v[172:175], v[104:111], v6
    v_exp_f32 v116, v116
    v_exp_f32 v117, v117
    v_mfma_f32_32x32x16_bf16 v[80:95], v[128:131], v[20:23], 0
    s_setprio 0
    v_exp_f32 v118, v118
    v_exp_f32 v119, v119
    ds_read_b64_tr_b16 v[158:159], v5 offset:19712
    v_exp_f32 v120, v120
    v_exp_f32 v121, v121
    v_mfma_f32_32x32x16_bf16 v[80:95], v[132:135], v[28:31], v[80:95]
    v_exp_f32 v122, v122
    v_exp_f32 v123, v123
    v_exp_f32 v124, v124
    v_exp_f32 v125, v125
    v_smfmac_f32_32x32x32_bf16 v[48:63], v[168:171], v[112:119], v6
    s_waitcnt vmcnt(0)
    ds_add_u32 v243, v246
    v_exp_f32 v126, v126
    v_exp_f32 v127, v127
    v_exp_f32 v64, v64
    v_exp_f32 v65, v65
    v_smfmac_f32_32x32x32_bf16 v[48:63], v[172:175], v[120:127], v6
    s_setprio 3
    ds_read_b128 v[128:131], v4 offset:20480
    s_waitcnt lgkmcnt(6)
    v_exp_f32 v66, v66
    v_exp_f32 v67, v67
    v_exp_f32 v68, v68
    v_exp_f32 v69, v69
    v_mfma_f32_32x32x16_bf16 v[96:111], v[136:139], v[16:19], 0
    v_exp_f32 v70, v70
    v_exp_f32 v71, v71
    v_exp_f32 v72, v72
    v_exp_f32 v73, v73
    ds_read_b128 v[132:135], v4 offset:21504
    v_mfma_f32_32x32x16_bf16 v[96:111], v[140:143], v[24:27], v[96:111]
    ds_read_b64_tr_b16 v[160:161], v5 offset:20480
    v_exp_f32 v74, v74
    v_exp_f32 v75, v75
    s_add_u32 m0, s40, 0x8000
    s_mov_b64 exec, s[52:53]
    buffer_load_dwordx4 v2, s[24:27], s39 offen lds
    s_mov_b64 exec, -1
    v_exp_f32 v76, v76
    v_exp_f32 v77, v77
    v_smfmac_f32_32x32x32_bf16 v[32:47], v[144:147], v[64:71], v6
    ds_read_b64_tr_b16 v[162:163], v5 offset:20736
    v_exp_f32 v78, v78
    s_add_u32 m0, s40, 0x8080
    s_mov_b64 exec, s[52:53]
    buffer_load_dwordx4 v2, s[24:27], s39 offen offset:896 lds
    s_mov_b64 exec, -1
    v_exp_f32 v79, v79
    v_exp_f32 v80, v80
    v_exp_f32 v81, v81
    v_smfmac_f32_32x32x32_bf16 v[32:47], v[148:151], v[72:79], v6
    ds_read_b64_tr_b16 v[164:165], v5 offset:21504
    ds_read2_b64 v[176:179], v8 offset0:0 offset1:1
    v_exp_f32 v82, v82
    v_exp_f32 v83, v83
    v_exp_f32 v84, v84
    v_mfma_f32_32x32x16_bf16 v[112:127], v[136:139], v[20:23], 0
    v_exp_f32 v85, v85
    ds_read_b64_tr_b16 v[166:167], v5 offset:21760
    ds_read2_b64 v[180:183], v8 offset0:2 offset1:3
    v_mfma_f32_32x32x16_bf16 v[112:127], v[140:143], v[28:31], v[112:127]
    v_exp_f32 v86, v86
    v_exp_f32 v87, v87
    v_exp_f32 v88, v88
    ds_read2_b64 v[184:187], v8 offset0:4 offset1:5
    v_exp_f32 v89, v89
    v_exp_f32 v90, v90
    v_exp_f32 v91, v91
    v_exp_f32 v92, v92
    v_exp_f32 v93, v93
    v_smfmac_f32_32x32x32_bf16 v[48:63], v[144:147], v[80:87], v6
    s_setprio 2
    ds_read_b64 v[188:189], v8 offset:48
    v_exp_f32 v94, v94
    v_exp_f32 v95, v95
    v_exp_f32 v96, v96
    v_exp_f32 v97, v97
    v_smfmac_f32_32x32x32_bf16 v[48:63], v[148:151], v[88:95], v6
    ds_read_b128 v[136:139], v4 offset:22528
    s_waitcnt lgkmcnt(1)
    ds_read_b64_tr_b16 v[192:193], v9 offset:0
    v_exp_f32 v98, v98
    v_exp_f32 v99, v99
    v_exp_f32 v100, v100
    v_mfma_f32_4x4x4_16b_bf16 v[208:211], v[176:177], v[176:177], 0
    v_exp_f32 v101, v101
    v_mfma_f32_32x32x16_bf16 v[64:79], v[128:131], v[16:19], 0
    ds_read_b128 v[140:143], v4 offset:23552
    ds_read_b64_tr_b16 v[194:195], v9 offset:8
    v_exp_f32 v102, v102
    v_exp_f32 v103, v103
    v_exp_f32 v104, v104
    v_mfma_f32_4x4x4_16b_bf16 v[208:211], v[178:179], v[178:179], v[208:211]
    v_exp_f32 v105, v105
    v_mfma_f32_32x32x16_bf16 v[64:79], v[132:135], v[24:27], v[64:79]
    s_setprio 2
    ds_read_b64_tr_b16 v[168:169], v5 offset:22528
    ds_read_b64_tr_b16 v[196:197], v9 offset:16
    v_exp_f32 v106, v106
    v_exp_f32 v107, v107
    v_exp_f32 v108, v108
    v_mfma_f32_4x4x4_16b_bf16 v[208:211], v[180:181], v[180:181], v[208:211]
    v_exp_f32 v109, v109
    v_smfmac_f32_32x32x32_bf16 v[32:47], v[152:155], v[96:103], v6
    ds_read_b64_tr_b16 v[170:171], v5 offset:22784
    ds_read_b64_tr_b16 v[198:199], v9 offset:24
    v_exp_f32 v110, v110
    v_exp_f32 v111, v111
    v_mfma_f32_4x4x4_16b_bf16 v[208:211], v[182:183], v[182:183], v[208:211]
    v_exp_f32 v112, v112
    v_exp_f32 v113, v113
    v_smfmac_f32_32x32x32_bf16 v[32:47], v[156:159], v[104:111], v6
    s_setprio 1
    ds_read_b64_tr_b16 v[172:173], v5 offset:23552
    v_exp_f32 v114, v114
    v_exp_f32 v115, v115
    v_mfma_f32_4x4x4_16b_bf16 v[208:211], v[184:185], v[184:185], v[208:211]
    v_exp_f32 v116, v116
    ds_read_b64_tr_b16 v[200:201], v9 offset:32
    v_exp_f32 v117, v117
    v_mfma_f32_32x32x16_bf16 v[80:95], v[128:131], v[20:23], 0
    ds_read_b64_tr_b16 v[202:203], v9 offset:40
    v_exp_f32 v118, v118
    v_exp_f32 v119, v119
    v_exp_f32 v120, v120
    v_mfma_f32_4x4x4_16b_bf16 v[208:211], v[186:187], v[186:187], v[208:211]
    v_exp_f32 v121, v121
    v_mfma_f32_32x32x16_bf16 v[80:95], v[132:135], v[28:31], v[80:95]
    ds_read_b64_tr_b16 v[174:175], v5 offset:23808
    s_setprio 0
    ds_read_b64_tr_b16 v[204:205], v9 offset:48
    ds_read_b32 v245, v244
    v_exp_f32 v122, v122
    v_exp_f32 v123, v123
    v_mfma_f32_4x4x4_16b_bf16 v[208:211], v[188:189], v[188:189], v[208:211]
    v_exp_f32 v124, v124
    v_exp_f32 v125, v125
    v_exp_f32 v126, v126
    v_smfmac_f32_32x32x32_bf16 v[48:63], v[152:155], v[112:119], v6
    v_exp_f32 v127, v127
    v_exp_f32 v64, v64
    s_waitcnt lgkmcnt(0)
    v_exp_f32 v65, v65
    v_smfmac_f32_32x32x32_bf16 v[48:63], v[156:159], v[120:127], v6
    s_setprio 3
    v_cmp_ge_u32 vcc, 5, v245
    s_cbranch_vccnz L_spinq5
L_backq5:
    ds_read_b128 v[128:131], v4 offset:32768
    v_exp_f32 v66, v66
    v_exp_f32 v67, v67
    v_cndmask_b32 v14, v208, v209, s[64:65]
    v_exp_f32 v68, v68
    ds_read_b128 v[132:135], v4 offset:33792
    v_cndmask_b32 v14, v14, v210, s[66:67]
    v_cndmask_b32 v14, v14, v211, s[68:69]
    v_exp_f32 v69, v69
    v_sqrt_f32 v14, v14
    v_exp_f32 v70, v70
    v_add_f32 v14, s44, v14
    v_mfma_f32_32x32x16_bf16 v[96:111], v[136:139], v[16:19], 0
    v_exp_f32 v71, v71
    v_exp_f32 v72, v72
    v_rcp_f32 v15, v14
    v_exp_f32 v73, v73
    v_mfma_f32_32x32x16_bf16 v[96:111], v[140:143], v[24:27], v[96:111]
    ds_read_b64_tr_b16 v[144:145], v5 offset:32768
    v_exp_f32 v74, v74
    v_cvt_pk_bf16_f32 v15, v15, v15
    v_and_b32 v206, v15, v10
    v_and_b32 v207, v15, v11
    v_exp_f32 v75, v75
    v_exp_f32 v76, v76
    v_mfma_f32_4x4x4_16b_bf16 v[208:211], v[192:193], v[206:207], 0
    v_exp_f32 v77, v77
    v_smfmac_f32_32x32x32_bf16 v[32:47], v[160:163], v[64:71], v6
    ds_read_b64_tr_b16 v[146:147], v5 offset:33024
    v_exp_f32 v78, v78
    v_exp_f32 v79, v79
    v_exp_f32 v80, v80
    v_exp_f32 v81, v81
    v_mfma_f32_4x4x4_16b_bf16 v[212:215], v[194:195], v[206:207], 0
    ds_read_b64_tr_b16 v[148:149], v5 offset:33792
    v_smfmac_f32_32x32x32_bf16 v[32:47], v[164:167], v[72:79], v6
    v_exp_f32 v82, v82
    v_exp_f32 v83, v83
    v_cvt_pk_bf16_f32 v176, v208, v209
    v_exp_f32 v84, v84
    v_mfma_f32_4x4x4_16b_bf16 v[216:219], v[196:197], v[206:207], 0
    v_cvt_pk_bf16_f32 v177, v210, v211
    v_exp_f32 v85, v85
    v_mfma_f32_32x32x16_bf16 v[112:127], v[136:139], v[20:23], 0
    ds_read_b64_tr_b16 v[150:151], v5 offset:34048
    v_exp_f32 v86, v86
    v_cvt_pk_bf16_f32 v178, v212, v213
    v_exp_f32 v87, v87
    v_exp_f32 v88, v88
    v_mfma_f32_4x4x4_16b_bf16 v[220:223], v[198:199], v[206:207], 0
    v_cvt_pk_bf16_f32 v179, v214, v215
    v_cvt_pk_bf16_f32 v180, v216, v217
    v_exp_f32 v89, v89
    v_mfma_f32_32x32x16_bf16 v[112:127], v[140:143], v[28:31], v[112:127]
    v_exp_f32 v90, v90
    v_exp_f32 v91, v91
    v_exp_f32 v92, v92
    v_mfma_f32_4x4x4_16b_bf16 v[224:227], v[200:201], v[206:207], 0
    v_exp_f32 v93, v93
    v_smfmac_f32_32x32x32_bf16 v[48:63], v[160:163], v[80:87], v6
    v_exp_f32 v94, v94
    v_exp_f32 v95, v95
    v_cvt_pk_bf16_f32 v181, v218, v219
    v_cvt_pk_bf16_f32 v182, v220, v221
    ds_read_b128 v[136:139], v4 offset:34816
    v_exp_f32 v96, v96
    v_mfma_f32_4x4x4_16b_bf16 v[228:231], v[202:203], v[206:207], 0
    v_mfma_f32_4x4x4_16b_bf16 v[232:235], v[204:205], v[206:207], 0
    v_exp_f32 v97, v97
    v_smfmac_f32_32x32x32_bf16 v[48:63], v[164:167], v[88:95], v6
    s_waitcnt lgkmcnt(5)
    s_setprio 2
    v_cvt_pk_bf16_f32 v183, v222, v223
    v_exp_f32 v98, v98
    v_exp_f32 v99, v99
    v_exp_f32 v100, v100
    v_cvt_pk_bf16_f32 v184, v224, v225
    v_mfma_f32_32x32x16_bf16 v[64:79], v[128:131], v[16:19], 0
    v_exp_f32 v101, v101
    ds_read_b128 v[140:143], v4 offset:35840
    ds_write_b128 v3, v[176:179] offset:32768
    v_exp_f32 v102, v102
    v_cvt_pk_bf16_f32 v185, v226, v227
    v_cvt_pk_bf16_f32 v186, v228, v229
    v_exp_f32 v103, v103
    v_exp_f32 v104, v104
    v_exp_f32 v105, v105
    v_mfma_f32_32x32x16_bf16 v[64:79], v[132:135], v[24:27], v[64:79]
    ds_write_b128 v3, v[180:183] offset:33280
    ds_read_b64_tr_b16 v[152:153], v5 offset:34816
    v_cvt_pk_bf16_f32 v187, v230, v231
    v_cvt_pk_bf16_f32 v188, v232, v233
    v_exp_f32 v106, v106
    v_exp_f32 v107, v107
    v_exp_f32 v108, v108
    v_exp_f32 v109, v109
    v_smfmac_f32_32x32x32_bf16 v[32:47], v[168:171], v[96:103], v6
    s_add_u32 s39, s39, 14336
    ds_read_b64_tr_b16 v[154:155], v5 offset:35072
    v_exp_f32 v110, v110
    v_cvt_pk_bf16_f32 v189, v234, v235
    v_exp_f32 v111, v111
    v_exp_f32 v112, v112
    v_exp_f32 v113, v113
    v_smfmac_f32_32x32x32_bf16 v[32:47], v[172:175], v[104:111], v6
    ds_read_b64_tr_b16 v[156:157], v5 offset:35840
    ds_write_b128 v3, v[184:187] offset:33792
    v_exp_f32 v114, v114
    v_exp_f32 v115, v115
    v_exp_f32 v116, v116
    v_exp_f32 v117, v117
    v_mfma_f32_32x32x16_bf16 v[80:95], v[128:131], v[20:23], 0
    ds_write_b128 v3, v[188:191] offset:34304
    v_exp_f32 v118, v118
    s_setprio 1
    v_exp_f32 v119, v119
    v_exp_f32 v120, v120
    v_exp_f32 v121, v121
    v_mfma_f32_32x32x16_bf16 v[80:95], v[132:135], v[28:31], v[80:95]
    s_setprio 0
    ds_read_b64_tr_b16 v[158:159], v5 offset:36096
    v_exp_f32 v122, v122
    v_exp_f32 v123, v123
    v_smfmac_f32_32x32x32_bf16 v[48:63], v[168:171], v[112:119], v6
    v_exp_f32 v124, v124
    v_exp_f32 v125, v125
    s_waitcnt vmcnt(0)
    ds_add_u32 v243, v246
    v_exp_f32 v126, v126
    v_exp_f32 v127, v127
    v_exp_f32 v64, v64
    v_exp_f32 v65, v65
    s_waitcnt lgkmcnt(9)
    ds_read_b128 v[128:131], v4 offset:36864
    v_exp_f32 v66, v66
    v_exp_f32 v67, v67
    v_exp_f32 v68, v68
    v_smfmac_f32_32x32x32_bf16 v[48:63], v[172:175], v[120:127], v6
    s_setprio 3
    v_exp_f32 v69, v69
    ds_read_b128 v[132:135], v4 offset:37888
    v_exp_f32 v70, v70
    v_mfma_f32_32x32x16_bf16 v[96:111], v[136:139], v[16:19], 0
    v_exp_f32 v71, v71
    v_exp_f32 v72, v72
    v_exp_f32 v73, v73
    v_mfma_f32_32x32x16_bf16 v[96:111], v[140:143], v[24:27], v[96:111]
    ds_read_b64_tr_b16 v[160:161], v5 offset:36864
    v_exp_f32 v74, v74
    v_exp_f32 v75, v75
    v_exp_f32 v76, v76
    v_exp_f32 v77, v77
    v_smfmac_f32_32x32x32_bf16 v[32:47], v[144:147], v[64:71], v6
    ds_read_b64_tr_b16 v[162:163], v5 offset:37120
    v_exp_f32 v78, v78
    v_exp_f32 v79, v79
    v_exp_f32 v80, v80
    v_exp_f32 v81, v81
    v_smfmac_f32_32x32x32_bf16 v[32:47], v[148:151], v[72:79], v6
    ds_read_b64_tr_b16 v[164:165], v5 offset:37888
    v_exp_f32 v82, v82
    v_exp_f32 v83, v83
    v_exp_f32 v84, v84
    v_exp_f32 v85, v85
    v_mfma_f32_32x32x16_bf16 v[112:127], v[136:139], v[20:23], 0
    v_exp_f32 v86, v86
    ds_read_b64_tr_b16 v[166:167], v5 offset:38144
    v_exp_f32 v87, v87
    v_exp_f32 v88, v88
    v_exp_f32 v89, v89
    v_mfma_f32_32x32x16_bf16 v[112:127], v[140:143], v[28:31], v[112:127]
    v_exp_f32 v90, v90
    v_exp_f32 v91, v91
    v_exp_f32 v92, v92
    v_exp_f32 v93, v93
    v_smfmac_f32_32x32x32_bf16 v[48:63], v[144:147], v[80:87], v6
    v_exp_f32 v94, v94
    v_exp_f32 v95, v95
    v_exp_f32 v96, v96
    v_exp_f32 v97, v97
    v_smfmac_f32_32x32x32_bf16 v[48:63], v[148:151], v[88:95], v6
    s_waitcnt lgkmcnt(4)
    ds_read_b128 v[136:139], v4 offset:38912
    s_setprio 2
    v_exp_f32 v98, v98
    v_exp_f32 v99, v99
    v_exp_f32 v100, v100
    v_exp_f32 v101, v101
    ds_read_b128 v[140:143], v4 offset:39936
    v_mfma_f32_32x32x16_bf16 v[64:79], v[128:131], v[16:19], 0
    v_exp_f32 v102, v102
    v_exp_f32 v103, v103
    v_exp_f32 v104, v104
    v_exp_f32 v105, v105
    v_mfma_f32_32x32x16_bf16 v[64:79], v[132:135], v[24:27], v[64:79]
    ds_read_b64_tr_b16 v[168:169], v5 offset:38912
    v_exp_f32 v106, v106
    v_exp_f32 v107, v107
    v_exp_f32 v108, v108
    s_setprio 1
    ds_read_b64_tr_b16 v[170:171], v5 offset:39168
    v_smfmac_f32_32x32x32_bf16 v[32:47], v[152:155], v[96:103], v6
    v_exp_f32 v109, v109
    v_exp_f32 v110, v110
    v_exp_f32 v111, v111
    v_exp_f32 v112, v112
    v_exp_f32 v113, v113
    v_smfmac_f32_32x32x32_bf16 v[32:47], v[156:159], v[104:111], v6
    ds_read_b64_tr_b16 v[172:173], v5 offset:39936
    v_exp_f32 v114, v114
    v_exp_f32 v115, v115
    v_exp_f32 v116, v116
    v_exp_f32 v117, v117
    v_mfma_f32_32x32x16_bf16 v[80:95], v[128:131], v[20:23], 0
    ds_read_b64_tr_b16 v[174:175], v5 offset:40192
    v_exp_f32 v118, v118
    v_exp_f32 v119, v119
    v_exp_f32 v120, v120
    v_exp_f32 v121, v121
    ds_read_b32 v245, v244
    s_setprio 0
    v_mfma_f32_32x32x16_bf16 v[80:95], v[132:135], v[28:31], v[80:95]
    v_exp_f32 v122, v122
    v_exp_f32 v123, v123
    v_smfmac_f32_32x32x32_bf16 v[48:63], v[152:155], v[112:119], v6
    v_exp_f32 v124, v124
    v_exp_f32 v125, v125
    v_exp_f32 v126, v126
    v_exp_f32 v127, v127
    v_exp_f32 v64, v64
    v_exp_f32 v65, v65
    v_smfmac_f32_32x32x32_bf16 v[48:63], v[156:159], v[120:127], v6
    s_waitcnt lgkmcnt(0)
    v_cmp_ge_u32 vcc, 6, v245
    s_cbranch_vccnz L_spinq6
L_backq6:
    v_exp_f32 v66, v66
    ds_read_b128 v[128:131], v4 offset:49152
    v_exp_f32 v67, v67
    v_exp_f32 v68, v68
    v_exp_f32 v69, v69
    v_mfma_f32_32x32x16_bf16 v[96:111], v[136:139], v[16:19], 0
    ds_read_b128 v[132:135], v4 offset:50176
    v_exp_f32 v70, v70
    v_exp_f32 v71, v71
    v_exp_f32 v72, v72
    v_exp_f32 v73, v73
    v_mfma_f32_32x32x16_bf16 v[96:111], v[140:143], v[24:27], v[96:111]
    s_setprio 2
    ds_read_b64_tr_b16 v[144:145], v5 offset:49152
    v_exp_f32 v74, v74
    v_exp_f32 v75, v75
    v_exp_f32 v76, v76
    v_exp_f32 v77, v77
    v_smfmac_f32_32x32x32_bf16 v[32:47], v[160:163], v[64:71], v6
    ds_read_b64_tr_b16 v[146:147], v5 offset:49408
    v_exp_f32 v78, v78
    v_exp_f32 v79, v79
    v_exp_f32 v80, v80
    v_exp_f32 v81, v81
    v_smfmac_f32_32x32x32_bf16 v[32:47], v[164:167], v[72:79], v6
    ds_read_b64_tr_b16 v[148:149], v5 offset:50176
    ds_read_b64_tr_b16 v[150:151], v5 offset:50432
    v_exp_f32 v82, v82
    v_exp_f32 v83, v83
    v_exp_f32 v84, v84
    v_exp_f32 v85, v85
    v_mfma_f32_32x32x16_bf16 v[112:127], v[136:139], v[20:23], 0
    v_exp_f32 v86, v86
    v_exp_f32 v87, v87
    v_mfma_f32_32x32x16_bf16 v[112:127], v[140:143], v[28:31], v[112:127]
    v_exp_f32 v88, v88
    v_exp_f32 v89, v89
    v_exp_f32 v90, v90
    v_exp_f32 v91, v91
    v_exp_f32 v92, v92
    v_smfmac_f32_32x32x32_bf16 v[48:63], v[160:163], v[80:87], v6
    v_exp_f32 v93, v93
    v_exp_f32 v94, v94
    v_exp_f32 v95, v95
    v_exp_f32 v96, v96
    v_exp_f32 v97, v97
    s_waitcnt lgkmcnt(4)
    ds_read_b128 v[136:139], v4 offset:51200
    v_smfmac_f32_32x32x32_bf16 v[48:63], v[164:167], v[88:95], v6
    v_exp_f32 v98, v98
    v_exp_f32 v99, v99
    v_mfma_f32_32x32x16_bf16 v[64:79], v[128:131], v[16:19], 0
    v_exp_f32 v100, v100
    v_exp_f32 v101, v101
    v_exp_f32 v102, v102
    v_exp_f32 v103, v103
    v_exp_f32 v104, v104
    ds_read_b128 v[140:143], v4 offset:52224
    v_exp_f32 v105, v105
    s_setprio 1
    v_mfma_f32_32x32x16_bf16 v[64:79], v[132:135], v[24:27], v[64:79]
    ds_read_b64_tr_b16 v[152:153], v5 offset:51200
    v_exp_f32 v106, v106
    v_exp_f32 v107, v107
    v_exp_f32 v108, v108
    v_exp_f32 v109, v109
    v_smfmac_f32_32x32x32_bf16 v[32:47], v[168:171], v[96:103], v6
    ds_read_b64_tr_b16 v[154:155], v5 offset:51456
    v_exp_f32 v110, v110
    v_exp_f32 v111, v111
    ds_read_b64_tr_b16 v[156:157], v5 offset:52224
    v_exp_f32 v112, v112
    v_exp_f32 v113, v113
    v_smfmac_f32_32x32x32_bf16 v[32:47], v[172:175], v[104:111], v6
    s_setprio 1
    v_exp_f32 v114, v114
    s_setprio 0
    v_exp_f32 v115, v115
    v_exp_f32 v116, v116
    v_exp_f32 v117, v117
    v_mfma_f32_32x32x16_bf16 v[80:95], v[128:131], v[20:23], 0
    ds_read_b64_tr_b16 v[158:159], v5 offset:52480
    v_exp_f32 v118, v118
    v_exp_f32 v119, v119
    v_exp_f32 v120, v120
    v_mfma_f32_32x32x16_bf16 v[80:95], v[132:135], v[28:31], v[80:95]
    v_exp_f32 v121, v121
    v_exp_f32 v122, v122
    v_exp_f32 v123, v123
    v_exp_f32 v124, v124
    v_exp_f32 v125, v125
    v_smfmac_f32_32x32x32_bf16 v[48:63], v[168:171], v[112:119], v6
    v_exp_f32 v126, v126
    v_exp_f32 v127, v127
    v_exp_f32 v64, v64
    v_exp_f32 v65, v65
    v_smfmac_f32_32x32x32_bf16 v[48:63], v[172:175], v[120:127], v6
    s_waitcnt lgkmcnt(4)
    v_exp_f32 v66, v66
    v_exp_f32 v67, v67
    s_setprio 2
    ds_read_b128 v[128:131], v4 offset:53248
    v_exp_f32 v68, v68
    v_exp_f32 v69, v69
    ds_read_b128 v[132:135], v4 offset:54272
    v_mfma_f32_32x32x16_bf16 v[96:111], v[136:139], v[16:19], 0
    s_setprio 2
    v_exp_f32 v70, v70
    v_exp_f32 v71, v71
    v_exp_f32 v72, v72
    ds_read_b64_tr_b16 v[160:161], v5 offset:53248
    v_exp_f32 v73, v73
    v_exp_f32 v74, v74
    v_mfma_f32_32x32x16_bf16 v[96:111], v[140:143], v[24:27], v[96:111]
    v_exp_f32 v75, v75
    v_exp_f32 v76, v76
    v_smfmac_f32_32x32x32_bf16 v[32:47], v[144:147], v[64:71], v6
    v_exp_f32 v77, v77
    ds_read_b64_tr_b16 v[162:163], v5 offset:53504
    v_exp_f32 v78, v78
    v_exp_f32 v79, v79
    v_exp_f32 v80, v80
    v_exp_f32 v81, v81
    ds_read_b64_tr_b16 v[164:165], v5 offset:54272
    ds_read_b64_tr_b16 v[166:167], v5 offset:54528
    v_exp_f32 v82, v82
    v_smfmac_f32_32x32x32_bf16 v[32:47], v[148:151], v[72:79], v6
    v_exp_f32 v83, v83
    v_mfma_f32_32x32x16_bf16 v[112:127], v[136:139], v[20:23], 0
    v_exp_f32 v84, v84
    v_exp_f32 v85, v85
    v_exp_f32 v86, v86
    v_mfma_f32_32x32x16_bf16 v[112:127], v[140:143], v[28:31], v[112:127]
    v_exp_f32 v87, v87
    v_exp_f32 v88, v88
    v_exp_f32 v89, v89
    v_exp_f32 v90, v90
    v_exp_f32 v91, v91
    v_exp_f32 v92, v92
    v_exp_f32 v93, v93
    v_smfmac_f32_32x32x32_bf16 v[48:63], v[144:147], v[80:87], v6
    v_exp_f32 v94, v94
    v_exp_f32 v95, v95
    v_exp_f32 v96, v96
    v_exp_f32 v97, v97
    v_smfmac_f32_32x32x32_bf16 v[48:63], v[148:151], v[88:95], v6
    s_waitcnt lgkmcnt(4)
    s_setprio 3
    ds_read_b128 v[136:139], v4 offset:55296
    v_exp_f32 v98, v98
    v_exp_f32 v99, v99
    ds_read_b128 v[140:143], v4 offset:56320
    v_exp_f32 v100, v100
    v_exp_f32 v101, v101
    v_mfma_f32_32x32x16_bf16 v[64:79], v[128:131], v[16:19], 0
    v_exp_f32 v102, v102
    v_exp_f32 v103, v103
    v_exp_f32 v104, v104
    v_exp_f32 v105, v105
    ds_read_b64_tr_b16 v[168:169], v5 offset:55296
    v_mfma_f32_32x32x16_bf16 v[64:79], v[132:135], v[24:27], v[64:79]
    v_exp_f32 v106, v106
    v_exp_f32 v107, v107
    v_exp_f32 v108, v108
    v_exp_f32 v109, v109
    v_smfmac_f32_32x32x32_bf16 v[32:47], v[152:155], v[96:103], v6
    ds_read_b64_tr_b16 v[170:171], v5 offset:55552
    v_exp_f32 v110, v110
    v_exp_f32 v111, v111
    v_exp_f32 v112, v112
    v_exp_f32 v113, v113
    v_smfmac_f32_32x32x32_bf16 v[32:47], v[156:159], v[104:111], v6
    s_setprio 1
    s_waitcnt lgkmcnt(2)
    ds_read_b64_tr_b16 v[172:173], v5 offset:56320
    v_exp_f32 v114, v114
    v_exp_f32 v115, v115
    v_exp_f32 v116, v116
    v_exp_f32 v117, v117
    v_mfma_f32_32x32x16_bf16 v[96:111], v[136:139], v[16:19], 0
    v_exp_f32 v118, v118
    v_exp_f32 v119, v119
    ds_read_b64_tr_b16 v[174:175], v5 offset:56576
    v_exp_f32 v120, v120
    v_exp_f32 v121, v121
    v_exp_f32 v122, v122
    v_mfma_f32_32x32x16_bf16 v[96:111], v[140:143], v[24:27], v[96:111]
    v_smfmac_f32_32x32x32_bf16 v[48:63], v[152:155], v[112:119], v6
    v_exp_f32 v123, v123
    v_exp_f32 v124, v124
    v_exp_f32 v125, v125
    s_setprio 0
    v_exp_f32 v126, v126
    v_exp_f32 v127, v127
    v_exp_f32 v64, v64
    v_exp_f32 v65, v65
    v_smfmac_f32_32x32x32_bf16 v[48:63], v[156:159], v[120:127], v6
    v_exp_f32 v66, v66
    v_exp_f32 v67, v67
    s_setprio 3
    v_exp_f32 v68, v68
    v_exp_f32 v69, v69
    v_mfma_f32_32x32x16_bf16 v[80:95], v[128:131], v[20:23], 0
    v_exp_f32 v70, v70
    v_exp_f32 v71, v71
    v_exp_f32 v72, v72
    v_exp_f32 v73, v73
    v_mfma_f32_32x32x16_bf16 v[80:95], v[132:135], v[28:31], v[80:95]
    v_exp_f32 v74, v74
    v_exp_f32 v75, v75
    v_exp_f32 v76, v76
    v_exp_f32 v77, v77
    v_smfmac_f32_32x32x32_bf16 v[32:47], v[160:163], v[64:71], v6
    v_exp_f32 v78, v78
    v_exp_f32 v79, v79
    v_exp_f32 v96, v96
    v_exp_f32 v97, v97
    v_smfmac_f32_32x32x32_bf16 v[32:47], v[164:167], v[72:79], v6
    s_waitcnt lgkmcnt(0)
    v_exp_f32 v98, v98
    v_exp_f32 v99, v99
    v_exp_f32 v100, v100
    v_exp_f32 v101, v101
    v_exp_f32 v102, v102
    v_mfma_f32_32x32x16_bf16 v[112:127], v[136:139], v[20:23], 0
    v_exp_f32 v103, v103
    v_exp_f32 v104, v104
    v_exp_f32 v105, v105
    v_exp_f32 v106, v106
    v_mfma_f32_32x32x16_bf16 v[112:127], v[140:143], v[28:31], v[112:127]
    v_exp_f32 v107, v107
    v_exp_f32 v108, v108
    v_exp_f32 v109, v109
    v_exp_f32 v110, v110
    v_smfmac_f32_32x32x32_bf16 v[32:47], v[168:171], v[96:103], v6
    v_exp_f32 v111, v111
    v_exp_f32 v80, v80
    v_exp_f32 v81, v81
    v_smfmac_f32_32x32x32_bf16 v[32:47], v[172:175], v[104:111], v6
    v_exp_f32 v82, v82
    v_exp_f32 v83, v83
    v_exp_f32 v84, v84
    v_exp_f32 v85, v85
    s_nop 0
    s_setprio 0
    v_exp_f32 v86, v86
    v_exp_f32 v87, v87
    v_exp_f32 v88, v88
    v_exp_f32 v89, v89
    v_smfmac_f32_32x32x32_bf16 v[48:63], v[160:163], v[80:87], v6
    s_nop 0
    ds_write_b128 v248, v[32:35] offset:0
    ds_write_b128 v248, v[36:39] offset:1024
    ds_write_b128 v248, v[40:43] offset:2048
    v_exp_f32 v90, v90
    ds_write_b128 v248, v[44:47] offset:3072
    v_exp_f32 v91, v91
    v_exp_f32 v92, v92
    v_exp_f32 v93, v93
    v_exp_f32 v94, v94
    v_exp_f32 v95, v95
    v_exp_f32 v112, v112
    v_exp_f32 v113, v113
    v_smfmac_f32_32x32x32_bf16 v[48:63], v[164:167], v[88:95], v6
    s_waitcnt lgkmcnt(0)
    s_barrier
    ds_read_b128 v[208:211], v249 offset:0
    v_exp_f32 v114, v114
    v_exp_f32 v115, v115
    ds_read_b128 v[212:215], v249 offset:1024
    v_exp_f32 v116, v116
    ds_read_b128 v[216:219], v249 offset:2048
    ds_read_b128 v[220:223], v249 offset:3072
    v_exp_f32 v117, v117
    v_exp_f32 v118, v118
    v_exp_f32 v119, v119
    v_exp_f32 v120, v120
    v_exp_f32 v121, v121
    s_waitcnt lgkmcnt(0)
    v_pk_add_f32 v[48:49], v[48:49], v[208:209]
    v_pk_add_f32 v[50:51], v[50:51], v[210:211]
    v_pk_add_f32 v[52:53], v[52:53], v[212:213]
    v_pk_add_f32 v[54:55], v[54:55], v[214:215]
    v_pk_add_f32 v[56:57], v[56:57], v[216:217]
    v_pk_add_f32 v[58:59], v[58:59], v[218:219]
    v_pk_add_f32 v[60:61], v[60:61], v[220:221]
    v_pk_add_f32 v[62:63], v[62:63], v[222:223]
    v_exp_f32 v122, v122
    v_exp_f32 v123, v123
    v_smfmac_f32_32x32x32_bf16 v[48:63], v[168:171], v[112:119], v6
    v_exp_f32 v124, v124
    v_exp_f32 v125, v125
    v_exp_f32 v126, v126
    v_exp_f32 v127, v127
    s_nop 1
    v_smfmac_f32_32x32x32_bf16 v[48:63], v[172:175], v[120:127], v6
    s_nop 0
L_fin:
    s_nop 10
    v_mov_b32 v13, v60
    s_nop 1
    v_permlane32_swap_b32 v60, v13
    v_rcp_f32 v206, v13
    s_nop 0
    v_pk_mul_f32 v[48:49], v[48:49], v[206:207] op_sel_hi:[1,0]
    v_pk_mul_f32 v[50:51], v[50:51], v[206:207] op_sel_hi:[1,0]
    v_cvt_pk_bf16_f32 v176, v48, v49
    v_cvt_pk_bf16_f32 v177, v50, v51
    ds_write_b64 v12, v[176:177] offset:0
    v_pk_mul_f32 v[52:53], v[52:53], v[206:207] op_sel_hi:[1,0]
    v_pk_mul_f32 v[54:55], v[54:55], v[206:207] op_sel_hi:[1,0]
    v_cvt_pk_bf16_f32 v178, v52, v53
    v_cvt_pk_bf16_f32 v179, v54, v55
    ds_write_b64 v12, v[178:179] offset:8
    v_pk_mul_f32 v[56:57], v[56:57], v[206:207] op_sel_hi:[1,0]
    v_pk_mul_f32 v[58:59], v[58:59], v[206:207] op_sel_hi:[1,0]
    v_cvt_pk_bf16_f32 v180, v56, v57
    v_cvt_pk_bf16_f32 v181, v58, v59
    ds_write_b64 v12, v[180:181] offset:16
    v_pk_mul_f32 v[60:61], v[60:61], v[206:207] op_sel_hi:[1,0]
    v_pk_mul_f32 v[62:63], v[62:63], v[206:207] op_sel_hi:[1,0]
    v_cvt_pk_bf16_f32 v182, v60, v61
    v_cvt_pk_bf16_f32 v183, v62, v63
    s_mov_b32 exec_hi, 0
    ds_write_b64 v12, v[182:183] offset:24
    s_mov_b32 exec_hi, -1
    ds_read_b128 v[208:211], v250
    ds_read_b128 v[212:215], v250 offset:1024
    s_waitcnt lgkmcnt(1)
    buffer_store_dwordx4 v[208:211], v1, s[28:31], s45 offen sc1
    s_mov_b32 exec_hi, 0xffff
    s_waitcnt lgkmcnt(0)
    buffer_store_dwordx4 v[212:215], v1, s[28:31], s45 offen offset:1024 sc1
L_end:
    s_endpgm
L_cold:
L_spinp0:
    s_sleep 1
    ds_read_b32 v245, v244
    s_waitcnt lgkmcnt(0)
    v_cmp_ge_u32 vcc, 0, v245
    s_cbranch_vccnz L_spinp0
    s_branch L_backp0
L_spinp1:
    s_sleep 1
    ds_read_b32 v245, v244
    s_waitcnt lgkmcnt(0)
    v_cmp_ge_u32 vcc, 1, v245
    s_cbranch_vccnz L_spinp1
    s_branch L_backp1
L_spinp2:
    s_sleep 1
    ds_read_b32 v245, v244
    s_waitcnt lgkmcnt(0)
    v_cmp_ge_u32 vcc, 2, v245
    s_cbranch_vccnz L_spinp2
    s_branch L_backp2
L_spinp3:
    s_sleep 1
    ds_read_b32 v245, v244
    s_waitcnt lgkmcnt(0)
    v_cmp_ge_u32 vcc, 3, v245
    s_cbranch_vccnz L_spinp3
    s_branch L_backp3
L_spinp4:
    s_sleep 1
    ds_read_b32 v245, v244
    s_waitcnt lgkmcnt(0)
    v_cmp_ge_u32 vcc, 4, v245
    s_cbranch_vccnz L_spinp4
    s_branch L_backp4
L_spinp5:
    s_sleep 1
    ds_read_b32 v245, v244
    s_waitcnt lgkmcnt(0)
    v_cmp_ge_u32 vcc, 5, v245
    s_cbranch_vccnz L_spinp5
    s_branch L_backp5
L_spinp6:
    s_sleep 1
    ds_read_b32 v245, v244
    s_waitcnt lgkmcnt(0)
    v_cmp_ge_u32 vcc, 6, v245
    s_cbranch_vccnz L_spinp6
    s_branch L_backp6
L_spinq0:
    s_sleep 1
    ds_read_b32 v245, v244
    s_waitcnt lgkmcnt(0)
    v_cmp_ge_u32 vcc, 0, v245
    s_cbranch_vccnz L_spinq0
    s_branch L_backq0
L_spinq1:
    s_sleep 1
    ds_read_b32 v245, v244
    s_waitcnt lgkmcnt(0)
    v_cmp_ge_u32 vcc, 1, v245
    s_cbranch_vccnz L_spinq1
    s_branch L_backq1
L_spinq2:
    s_sleep 1
    ds_read_b32 v245, v244
    s_waitcnt lgkmcnt(0)
    v_cmp_ge_u32 vcc, 2, v245
    s_cbranch_vccnz L_spinq2
    s_branch L_backq2
L_spinq3:
    s_sleep 1
    ds_read_b32 v245, v244
    s_waitcnt lgkmcnt(0)
    v_cmp_ge_u32 vcc, 3, v245
    s_cbranch_vccnz L_spinq3
    s_branch L_backq3
L_spinq4:
    s_sleep 1
    ds_read_b32 v245, v244
    s_waitcnt lgkmcnt(0)
    v_cmp_ge_u32 vcc, 4, v245
    s_cbranch_vccnz L_spinq4
    s_branch L_backq4
L_spinq5:
    s_sleep 1
    ds_read_b32 v245, v244
    s_waitcnt lgkmcnt(0)
    v_cmp_ge_u32 vcc, 5, v245
    s_cbranch_vccnz L_spinq5
    s_branch L_backq5
L_spinq6:
    s_sleep 1
    ds_read_b32 v245, v244
    s_waitcnt lgkmcnt(0)
    v_cmp_ge_u32 vcc, 6, v245
    s_cbranch_vccnz L_spinq6
    s_branch L_backq6
L_special:
    s_cmp_eq_u32 s56, 0
    s_cbranch_scc1 L_maxpass
    s_waitcnt lgkmcnt(0)
    s_mov_b32 exec_lo, 0
    v_mov_b32 v26, v236
    v_mov_b32 v27, v237
    v_mov_b32 v30, v238
    v_mov_b32 v31, v239
    s_mov_b32 exec_lo, -1
    s_nop 1
    s_branch L_fill
L_maxpass:
    v_mov_b32 v236, 0xff800000
    v_mov_b32 v238, 0xff800000
    s_cmp_eq_u32 s35, 0
    s_cselect_b32 s46, 28672, 0
    s_sub_u32 s38, s38, s46
L_mloop:
    s_add_u32 s46, s37, s35
    s_bitcmp1_b32 s46, 0
    s_cbranch_scc1 L_mnoprep
    s_cmp_eq_u32 s37, 7
    s_cbranch_scc1 L_mnoprep
    s_cmp_eq_u32 s37, 1
    s_cbranch_scc1 L_mhave
    s_mov_b32 m0, s41
    s_nop 0
    buffer_load_dwordx4 v1, s[20:23], s38 offen offset:0 lds
    buffer_load_dwordx4 v1, s[20:23], s38 offen offset:1024 lds
    buffer_load_dwordx4 v1, s[20:23], s38 offen offset:2048 lds
    s_mov_b32 exec_hi, 0
    buffer_load_dwordx4 v1, s[20:23], s38 offen offset:3072 lds
    s_mov_b32 exec_hi, -1
    s_add_u32 s38, s38, 28672
L_mhave:
    s_waitcnt vmcnt(0) lgkmcnt(0)
    s_call_b64 s[54:55], L_prep
L_mnoprep:
    ds_read_b128 v[128:131], v4 offset:0
    ds_read_b128 v[132:135], v4 offset:1024
    s_waitcnt lgkmcnt(0)
    v_mfma_f32_32x32x16_bf16 v[64:79], v[128:131], v[16:19], 0
    v_mfma_f32_32x32x16_bf16 v[64:79], v[132:135], v[24:27], v[64:79]
    v_mfma_f32_32x32x16_bf16 v[80:95], v[128:131], v[20:23], 0
    v_mfma_f32_32x32x16_bf16 v[80:95], v[132:135], v[28:31], v[80:95]
    s_nop 15
    v_max3_f32 v236, v64, v65, v236
    v_max3_f32 v236, v66, v67, v236
    v_max3_f32 v236, v68, v69, v236
    v_max3_f32 v236, v70, v71, v236
    v_max3_f32 v236, v72, v73, v236
    v_max3_f32 v236, v74, v75, v236
    v_max3_f32 v236, v76, v77, v236
    v_max3_f32 v236, v78, v79, v236
    v_max3_f32 v238, v80, v81, v238
    v_max3_f32 v238, v82, v83, v238
    v_max3_f32 v238, v84, v85, v238
    v_max3_f32 v238, v86, v87, v238
    v_max3_f32 v238, v88, v89, v238
    v_max3_f32 v238, v90, v91, v238
    v_max3_f32 v238, v92, v93, v238
    v_max3_f32 v238, v94, v95, v238
    ds_read_b128 v[128:131], v4 offset:2048
    ds_read_b128 v[132:135], v4 offset:3072
    s_waitcnt lgkmcnt(0)
    v_mfma_f32_32x32x16_bf16 v[64:79], v[128:131], v[16:19], 0
    v_mfma_f32_32x32x16_bf16 v[64:79], v[132:135], v[24:27], v[64:79]
    v_mfma_f32_32x32x16_bf16 v[80:95], v[128:131], v[20:23], 0
    v_mfma_f32_32x32x16_bf16 v[80:95], v[132:135], v[28:31], v[80:95]
    s_nop 15
    v_max3_f32 v236, v64, v65, v236
    v_max3_f32 v236, v66, v67, v236
    v_max3_f32 v236, v68, v69, v236
    v_max3_f32 v236, v70, v71, v236
    v_max3_f32 v236, v72, v73, v236
    v_max3_f32 v236, v74, v75, v236
    v_max3_f32 v236, v76, v77, v236
    v_max3_f32 v236, v78, v79, v236
    v_max3_f32 v238, v80, v81, v238
    v_max3_f32 v238, v82, v83, v238
    v_max3_f32 v238, v84, v85, v238
    v_max3_f32 v238, v86, v87, v238
    v_max3_f32 v238, v88, v89, v238
    v_max3_f32 v238, v90, v91, v238
    v_max3_f32 v238, v92, v93, v238
    v_max3_f32 v238, v94, v95, v238
    ds_read_b128 v[128:131], v4 offset:4096
    ds_read_b128 v[132:135], v4 offset:5120
    s_waitcnt lgkmcnt(0)
    v_mfma_f32_32x32x16_bf16 v[64:79], v[128:131], v[16:19], 0
    v_mfma_f32_32x32x16_bf16 v[64:79], v[132:135], v[24:27], v[64:79]
    v_mfma_f32_32x32x16_bf16 v[80:95], v[128:131], v[20:23], 0
    v_mfma_f32_32x32x16_bf16 v[80:95], v[132:135], v[28:31], v[80:95]
    s_nop 15
    v_max3_f32 v236, v64, v65, v236
    v_max3_f32 v236, v66, v67, v236
    v_max3_f32 v236, v68, v69, v236
    v_max3_f32 v236, v70, v71, v236
    v_max3_f32 v236, v72, v73, v236
    v_max3_f32 v236, v74, v75, v236
    v_max3_f32 v236, v76, v77, v236
    v_max3_f32 v236, v78, v79, v236
    v_max3_f32 v238, v80, v81, v238
    v_max3_f32 v238, v82, v83, v238
    v_max3_f32 v238, v84, v85, v238
    v_max3_f32 v238, v86, v87, v238
    v_max3_f32 v238, v88, v89, v238
    v_max3_f32 v238, v90, v91, v238
    v_max3_f32 v238, v92, v93, v238
    v_max3_f32 v238, v94, v95, v238
    ds_read_b128 v[128:131], v4 offset:6144
    ds_read_b128 v[132:135], v4 offset:7168
    s_waitcnt lgkmcnt(0)
    v_mfma_f32_32x32x16_bf16 v[64:79], v[128:131], v[16:19], 0
    v_mfma_f32_32x32x16_bf16 v[64:79], v[132:135], v[24:27], v[64:79]
    v_mfma_f32_32x32x16_bf16 v[80:95], v[128:131], v[20:23], 0
    v_mfma_f32_32x32x16_bf16 v[80:95], v[132:135], v[28:31], v[80:95]
    s_nop 15
    v_max3_f32 v236, v64, v65, v236
    v_max3_f32 v236, v66, v67, v236
    v_max3_f32 v236, v68, v69, v236
    v_max3_f32 v236, v70, v71, v236
    v_max3_f32 v236, v72, v73, v236
    v_max3_f32 v236, v74, v75, v236
    v_max3_f32 v236, v76, v77, v236
    v_max3_f32 v236, v78, v79, v236
    v_max3_f32 v238, v80, v81, v238
    v_max3_f32 v238, v82, v83, v238
    v_max3_f32 v238, v84, v85, v238
    v_max3_f32 v238, v86, v87, v238
    v_max3_f32 v238, v88, v89, v238
    v_max3_f32 v238, v90, v91, v238
    v_max3_f32 v238, v92, v93, v238
    v_max3_f32 v238, v94, v95, v238
    s_barrier
    v_xor_b32 v4, s59, v4
    s_xor_b32 s59, s59, 0x8000
    s_add_u32 s37, s37, 1
    s_cmp_lt_u32 s37, 8
    s_cbranch_scc1 L_mloop
    v_mov_b32 v7, v236
    s_nop 1
    v_permlane32_swap_b32 v236, v7
    s_nop 1
    v_max_f32 v236, v236, v7
    v_mov_b32 v7, v238
    s_nop 1
    v_permlane32_swap_b32 v238, v7
    s_nop 1
    v_max_f32 v238, v238, v7
    s_lshl_b32 s46, s32, 12
    s_add_u32 s46, s46, 65536
    v_add_u32 v7, s46, v1
    v_xor_b32 v13, 0x4000, v7
    s_waitcnt vmcnt(0) lgkmcnt(0)
    ds_write_b32 v7, v236
    ds_write_b32 v7, v238 offset:4
    s_waitcnt lgkmcnt(0)
    s_barrier
    ds_read_b64 v[208:209], v13
    s_waitcnt lgkmcnt(0)
    s_barrier
    s_mov_b32 s46, 0xffff0000
    v_max_f32 v236, v236, v209
    v_sub_f32 v236, 0, v236
    v_and_b32 v7, s46, v236
    v_sub_f32 v236, v236, v7
    v_and_b32 v13, s46, v236
    v_sub_f32 v236, v236, v13
    v_lshrrev_b32 v237, 16, v236
    v_lshrrev_b32 v7, 16, v7
    v_or_b32 v236, v7, v13
    v_max_f32 v238, v238, v208
    v_sub_f32 v238, 0, v238
    v_and_b32 v7, s46, v238
    v_sub_f32 v238, v238, v7
    v_and_b32 v13, s46, v238
    v_sub_f32 v238, v238, v13
    v_lshrrev_b32 v239, 16, v238
    v_lshrrev_b32 v7, 16, v7
    v_or_b32 v238, v7, v13
    s_mov_b32 s56, 1
    s_branch L_restart
.section .rodata,"a"
.p2align 6
.amdhsa_kernel standalone__qk_norm__prompt_kernel
  .amdhsa_next_free_vgpr 253
  .amdhsa_next_free_sgpr 72
  .amdhsa_accum_offset 256
  .amdhsa_group_segment_fixed_size 0
  .amdhsa_kernarg_size 56
  .amdhsa_user_sgpr_count 2
  .amdhsa_user_sgpr_kernarg_segment_ptr 1
  .amdhsa_system_sgpr_workgroup_id_x 1
.end_amdhsa_kernel
```
